```python
import torch

def _softmax(x, axis=-1):
    return torch.softmax(x, dim=axis)
def _gelu(x):
    return torch.nn.functional.gelu(x, approximate="tanh")
def _silu(x):
    return torch.nn.functional.silu(x)
def _sigmoid(x):
    return torch.sigmoid(x)
def _layernorm(x, axis=-1, eps=1e-5):
    m = x.mean(dim=axis, keepdim=True)
    v = x.var(dim=axis, keepdim=True, unbiased=False)
    return (x - m) / torch.sqrt(v + eps)
def _scatter_add(tgt, idx, src, axis=0):
    return tgt.clone().index_add_(axis, idx, src)
def _segment_sum(src, seg, n):
    out = torch.zeros((n,) + src.shape[1:], dtype=src.dtype)
    return out.index_add_(0, seg, src)
def _pad(x, pw):
    flat = tuple(v for pair in reversed(pw) for v in pair)
    return torch.nn.functional.pad(x, flat)

kernel_name = 'gated_mix__sliding_block_cached__mixer_channel_mlp__decode'

def setup_inputs():

    _w = (lambda a: (lambda t: t.to(torch.bfloat16) if t.is_floating_point() else t)(torch.as_tensor(a)))
    def _A_setup():
        B, Sq, D = 8, 1, 576
        Hq, Hkv, Sk, Dh = 32, 16, 8192, 128
        assert Hq % Hkv == 0, (Hq, Hkv)
        return {
            "x": _w((lambda *s: torch.randn(*s, dtype=torch.bfloat16) * 0.05)(B, Sq, D)),
            "k_cache": _w((lambda *s: torch.randn(*s, dtype=torch.bfloat16) * 6.4)(B, Hkv, Sk, Dh)),
            "v_cache": _w((lambda *s: torch.randn(*s, dtype=torch.bfloat16) * 0.4)(B, Hkv, Sk, Dh)),
            "wq": _w((lambda *s: torch.randn(*s, dtype=torch.bfloat16) * 6.4)(D, Hq * Dh) * (D ** -0.5)),
            "wo": _w((lambda *s: torch.randn(*s, dtype=torch.bfloat16) * 0.4)(Hq * Dh, D) * ((Hq * Dh) ** -0.5)),
        }
    _A_in = _A_setup()

    def _B_setup():
        B, S, D, F = 8, 1, 576, 4608
        return {
            "x": _w((lambda *s: torch.randn(*s, dtype=torch.bfloat16) * 0.05)(B, S, D)),
            "w1": _w((lambda *s: torch.randn(*s, dtype=torch.bfloat16) * 0.8)(D, F) * (D ** -0.5)),
            "b1": _w((lambda *s: torch.randn(*s, dtype=torch.bfloat16) * 0.8)(F)),
            "w2": _w((lambda *s: torch.randn(*s, dtype=torch.bfloat16) * 0.05)(F, D) * (F ** -0.5)),
            "b2": _w((lambda *s: torch.randn(*s, dtype=torch.bfloat16) * 0.05)(D)),
        }
    _B_in = _B_setup()

    return {
        "A_x": _A_in["x"],
        "A_k_cache": _A_in["k_cache"],
        "A_v_cache": _A_in["v_cache"],
        "A_wq": _A_in["wq"],
        "A_wo": _A_in["wo"],
        "B_x": _B_in["x"],
        "B_w1": _B_in["w1"],
        "B_b1": _B_in["b1"],
        "B_w2": _B_in["w2"],
        "B_b2": _B_in["b2"],
        "gate_w": _w((lambda *s: torch.randn(*s, dtype=torch.bfloat16) * 0.05)(576) * 16.0),
    }

def reference(A_x, A_k_cache, A_v_cache, A_wq, A_wo, B_x, B_w1, B_b1, B_w2, B_b2, gate_w):
    def _A_ref(x, k_cache, v_cache, wq, wo):
        B, Sq, D = x.shape
        Hq, Dh = 32, 128
        Hkv, Sk = k_cache.shape[1], k_cache.shape[2]
        W = min(4096, max(256, Sk // 4))
        rep = Hq // Hkv
        q = (lambda x, *d: x.permute(*d))((x @ wq).reshape(B, Sq, Hq, Dh), 0, 2, 1, 3)
        k = (lambda x, n, axis: torch.repeat_interleave(x, n, dim=axis))(k_cache[:, :, Sk - W:, :], rep, axis=1)
        v = (lambda x, n, axis: torch.repeat_interleave(x, n, dim=axis))(v_cache[:, :, Sk - W:, :], rep, axis=1)
        scores = torch.einsum("bhqd,bhkd->bhqk", q, k) * (Dh ** -0.5)
        p = _softmax(scores, axis=-1)
        o = torch.einsum("bhqk,bhkd->bhqd", p, v)
        return (lambda x, *d: x.permute(*d))(o, 0, 2, 1, 3).reshape(B, Sq, Hq * Dh) @ wo

    def _B_ref(x, w1, b1, w2, b2):
        y = _layernorm(x, axis=-1)
        h = _gelu(torch.einsum("bsd,df->bsf", y, w1) + b1)
        return torch.einsum("bsf,fd->bsd", h, w2) + b2

    x = A_x
    g = _sigmoid((x * gate_w).sum(-1, keepdims=True))
    a = _A_ref(x, A_k_cache, A_v_cache, A_wq, A_wo)
    b = _B_ref(x, B_w1, B_b1, B_w2, B_b2)
    return g * a + (1 - g) * b
```

```asm
; @launch grid=(256,1,1) block=(512,1,1) lds=47360
.amdgcn_target "amdgcn-amd-amdhsa--gfx950"
.text
.globl gated_mix__sliding_block_cached__mixer_channel_mlp__decode_kernel
.p2align 8
.type gated_mix__sliding_block_cached__mixer_channel_mlp__decode_kernel,@function
gated_mix__sliding_block_cached__mixer_channel_mlp__decode_kernel:
    s_load_dwordx16 s[64:79], s[0:1], 0
    s_load_dwordx2 s[12:13], s[0:1], 104
    s_load_dwordx2 s[20:21], s[0:1], 64
    s_cmpk_ge_u32 s2, 256
    s_cbranch_scc1 L_end
    v_and_b32 v2, 7, v0
    v_lshlrev_b32 v2, 2, v2
    v_mov_b32 v3, 0
    ds_write_b32 v2, v3 offset:47296
    s_lshr_b32 s49, s2, 4
    s_cmp_lt_u32 s49, 8
    s_cselect_b32 s46, 0, 15
    s_bitcmp1_b32 s2, 3
    s_cselect_b32 s46, s46, 8
    s_add_u32 s49, s49, s46
    s_lshr_b32 s46, s2, 3
    s_cmp_ge_u32 s46, 30
    s_cselect_b32 s49, s46, s49
    s_and_b32 s48, s2, 7
    s_cmp_lt_u32 s49, 8
    s_cbranch_scc1 L_role_Q
    s_cmp_lt_u32 s49, 17
    s_cbranch_scc1 L_role_H
    s_cmp_lt_u32 s49, 26
    s_cbranch_scc1 L_role_Y
    s_cmp_eq_u32 s49, 31
    s_cbranch_scc1 L_role_Q
    s_cmp_eq_u32 s49, 30
    s_cbranch_scc1 L_role_H
    s_lshl3_add_u32 s46, s49, s48
    s_cmpk_eq_u32 s46, 235
    s_cbranch_scc1 L_role_H
    s_cmpk_eq_u32 s46, 239
    s_cbranch_scc1 L_role_Q
L_role_C:
    s_waitcnt lgkmcnt(0)
    s_load_dword s40, s[12:13], 0
    s_mov_b64 s[24:25], s[64:65]
    s_mov_b64 s[16:17], s[72:73]
    v_lshrrev_b32 v5, 6, v0
    v_and_b32 v1, 63, v0
    s_nop 0
    v_readfirstlane_b32 s44, v5
    v_lshlrev_b32 v0, 4, v1
    s_mov_b32 s26, 0x2400
    s_mov_b32 s27, 0x20000
    s_mov_b32 s18, 0x480000
    s_mov_b32 s19, 0x20000
    s_sub_u32 s49, s49, 26
    s_lshl_b32 s52, s49, 3
    s_add_u32 s52, s52, s44
    s_mul_i32 s52, s52, 18432
    s_mul_i32 s46, s48, 589824
    s_add_u32 s52, s52, s46
    buffer_load_dwordx4 v[176:179], v0, s[16:19], s52 offen offset:0
    buffer_load_dwordx4 v[180:183], v0, s[16:19], s52 offen offset:1024
    buffer_load_dwordx4 v[184:187], v0, s[16:19], s52 offen offset:2048
    buffer_load_dwordx4 v[188:191], v0, s[16:19], s52 offen offset:3072
    s_add_u32 s52, s52, 4096
    buffer_load_dwordx4 v[192:195], v0, s[16:19], s52 offen offset:0
    s_mov_b64 s[4:5], s[66:67]
    s_mov_b64 s[8:9], s[68:69]
    s_barrier
    s_mov_b32 s10, 0x10000000
    s_mov_b32 s11, 0x20000
    s_mov_b32 s14, 0x168000
    s_mov_b32 s15, 0x20000
    s_and_b32 s60, s2, 7
    s_bfe_u32 s61, s2, 0x10004
    s_lshl1_add_u32 s60, s60, s61
    s_lshr_b32 s61, s2, 5
    s_bfe_u32 s62, s2, 0x10003
    s_lshl4_add_u32 s63, s61, s60
    s_lshl_b32 s64, s63, 21
    s_add_u32 s64, s64, 0x180000
    s_lshl_b32 s63, s63, 1
    s_lshl_b32 s46, s62, 12
    s_add_u32 s64, s64, s46
    s_bfe_u32 s46, s44, 0x10000
    s_lshl_b32 s46, s46, 13
    s_add_u32 s64, s64, s46
    s_bfe_u32 s46, s44, 0x10001
    s_lshl_b32 s46, s46, 14
    s_add_u32 s64, s64, s46
    s_bfe_u32 s46, s44, 0x10002
    s_lshl_b32 s46, s46, 15
    s_add_u32 s64, s64, s46
    v_bfe_u32 v2, v1, 2, 1
    v_lshlrev_b32 v2, 8, v2
    v_bfe_u32 v5, v1, 3, 1
    v_lshl_add_u32 v2, v5, 9, v2
    v_lshrrev_b32 v5, 4, v1
    v_lshl_add_u32 v2, v5, 6, v2
    v_and_b32 v5, 3, v1
    v_lshl_add_u32 v2, v5, 4, v2
    s_mov_b32 s6, 0x10000000
    s_mov_b32 s7, 0x20000
    s_and_b32 s46, s64, 0xfff80000
    s_cmp_eq_u32 s44, 1
    s_cselect_b32 s46, s46, 0x40000000
    s_mul_i32 s47, s60, 294912
    s_cmp_eq_u32 s44, 1
    s_cselect_b32 s47, s47, 0x40000000
    v_mul_u32_u24 v250, 524288, v1
    v_mul_u32_u24 v248, 294912, v1
    s_mov_b64 exec, 0x1
    buffer_load_dword v251, v250, s[4:7], s46 offen nt
    buffer_load_dword v251, v250, s[8:11], s46 offen nt
    buffer_load_dword v251, v248, s[16:19], s47 offen
    s_mov_b64 exec, -1
    s_mov_b32 s101, 0
    s_and_b32 s55, s2, 7
    s_lshr_b32 s56, s2, 3
    s_cmp_ge_u32 s56, 14
    s_cselect_b32 s54, 1, 0
    s_cmp_eq_u32 s44, 7
    s_cselect_b32 s54, s54, 0
    s_sub_u32 s56, s56, 14
    s_mov_b32 s65, 0
    s_getreg_b32 s47, hwreg(HW_REG_XCC_ID)
    s_and_b32 s47, s47, 15
    s_lshr_b32 s65, 0x55, s47
    s_and_b32 s65, s65, 1
    s_lshl_b32 s79, s55, 7
    s_lshr_b32 s46, s2, 3
    s_lshl_b32 s46, s46, 2
    s_add_u32 s46, s46, s79
    s_cmp_eq_u32 s44, 0
    s_cselect_b32 s46, s46, 0x40000000
    v_and_b32 v249, 31, v1
    v_lshlrev_b32 v249, 2, v249
    s_waitcnt lgkmcnt(0)
    s_add_u32 s40, s40, 0x01010101
    s_andn2_b32 s78, s40, 15
    s_or_b32 s78, s78, s47
    v_mov_b32 v248, s78
    s_mov_b64 exec, 1
    buffer_store_dword v248, v249, s[12:15], s46 offen offset:1024
    s_mov_b64 exec, -1
    s_lshr_b32 s41, s40, 8
    s_lshl_b32 s46, s40, 24
    s_or_b32 s41, s41, s46
    s_lshr_b32 s42, s40, 16
    s_lshl_b32 s46, s40, 16
    s_or_b32 s42, s42, s46
    s_lshr_b32 s43, s40, 24
    s_lshl_b32 s46, s40, 8
    s_or_b32 s43, s43, s46
    s_and_b32 s28, s40, 0xff
    s_and_b32 s29, s41, 0xff
    s_and_b32 s30, s42, 0xff
    s_and_b32 s31, s43, 0xff
    s_waitcnt vmcnt(8)
    buffer_load_dwordx4 v[196:199], v0, s[16:19], s52 offen offset:1024
    s_waitcnt vmcnt(8)
    buffer_load_dwordx4 v[200:203], v0, s[16:19], s52 offen offset:2048
    s_waitcnt vmcnt(8)
    buffer_load_dwordx4 v[204:207], v0, s[16:19], s52 offen offset:3072
    s_add_u32 s52, s52, 4096
    s_waitcnt vmcnt(8)
    buffer_load_dwordx4 v[208:211], v0, s[16:19], s52 offen offset:0
    s_waitcnt vmcnt(8)
    buffer_load_dwordx4 v[212:215], v0, s[16:19], s52 offen offset:1024
    s_waitcnt vmcnt(4)
    buffer_load_dwordx4 v[216:219], v0, s[16:19], s52 offen offset:2048
    s_waitcnt vmcnt(4)
    buffer_load_dwordx4 v[48:51], v2, s[4:7], s64 offen offset:0 nt
    s_waitcnt vmcnt(4)
    buffer_load_dwordx4 v[52:55], v2, s[4:7], s64 offen offset:1024 nt
    s_waitcnt vmcnt(4)
    s_cmp_eq_u32 s65, 0
    s_cbranch_scc1 L_nt_1
    s_waitcnt vmcnt(3)
L_nt_1:
    buffer_load_dwordx4 v[56:59], v2, s[4:7], s64 offen offset:2048 nt
    s_waitcnt vmcnt(4)
    s_cmp_eq_u32 s65, 0
    s_cbranch_scc1 L_nt_2
    s_waitcnt vmcnt(3)
L_nt_2:
    buffer_load_dwordx4 v[60:63], v2, s[4:7], s64 offen offset:3072 nt
    s_waitcnt vmcnt(4)
    s_cmp_eq_u32 s65, 0
    s_cbranch_scc1 L_nt_3
    s_waitcnt vmcnt(3)
L_nt_3:
    s_add_u32 s46, s64, 0x10000
    buffer_load_dwordx4 v[64:67], v2, s[4:7], s46 offen offset:0 nt
    s_waitcnt vmcnt(4)
    s_cmp_eq_u32 s65, 0
    s_cbranch_scc1 L_nt_4
    s_waitcnt vmcnt(3)
L_nt_4:
    s_add_u32 s46, s64, 0x10000
    buffer_load_dwordx4 v[68:71], v2, s[4:7], s46 offen offset:1024 nt
    s_waitcnt vmcnt(4)
    s_cmp_eq_u32 s65, 0
    s_cbranch_scc1 L_nt_5
    s_waitcnt vmcnt(3)
L_nt_5:
    s_add_u32 s46, s64, 0x10000
    buffer_load_dwordx4 v[72:75], v2, s[4:7], s46 offen offset:2048 nt
    s_waitcnt vmcnt(4)
    s_cmp_eq_u32 s65, 0
    s_cbranch_scc1 L_nt_6
    s_waitcnt vmcnt(3)
L_nt_6:
    s_add_u32 s46, s64, 0x10000
    buffer_load_dwordx4 v[76:79], v2, s[4:7], s46 offen offset:3072 nt
    s_waitcnt vmcnt(4)
    s_cmp_eq_u32 s65, 0
    s_cbranch_scc1 L_nt_7
    s_waitcnt vmcnt(3)
L_nt_7:
    s_add_u32 s46, s64, 0x20000
    buffer_load_dwordx4 v[80:83], v2, s[4:7], s46 offen offset:0 nt
    s_waitcnt vmcnt(4)
    s_cmp_eq_u32 s65, 0
    s_cbranch_scc1 L_nt_8
    s_waitcnt vmcnt(3)
L_nt_8:
    s_add_u32 s46, s64, 0x20000
    buffer_load_dwordx4 v[84:87], v2, s[4:7], s46 offen offset:1024 nt
    s_waitcnt vmcnt(4)
    s_cmp_eq_u32 s65, 0
    s_cbranch_scc1 L_nt_9
    s_waitcnt vmcnt(3)
L_nt_9:
    s_add_u32 s46, s64, 0x20000
    buffer_load_dwordx4 v[88:91], v2, s[4:7], s46 offen offset:2048 nt
    s_waitcnt vmcnt(4)
    s_cmp_eq_u32 s65, 0
    s_cbranch_scc1 L_nt_10
    s_waitcnt vmcnt(3)
L_nt_10:
    s_add_u32 s46, s64, 0x20000
    buffer_load_dwordx4 v[92:95], v2, s[4:7], s46 offen offset:3072 nt
    s_waitcnt vmcnt(4)
    s_cmp_eq_u32 s65, 0
    s_cbranch_scc1 L_nt_11
    s_waitcnt vmcnt(3)
L_nt_11:
    s_add_u32 s46, s64, 0x30000
    buffer_load_dwordx4 v[96:99], v2, s[4:7], s46 offen offset:0 nt
    buffer_load_dword v250, v249, s[12:15], s79 offen offset:1024 sc1
    s_waitcnt vmcnt(5)
    s_cmp_eq_u32 s65, 0
    s_cbranch_scc1 L_nt_12
    s_waitcnt vmcnt(4)
L_nt_12:
    s_add_u32 s46, s64, 0x30000
    buffer_load_dwordx4 v[100:103], v2, s[4:7], s46 offen offset:1024 nt
    s_waitcnt vmcnt(5)
    s_cmp_eq_u32 s65, 0
    s_cbranch_scc1 L_nt_13
    s_waitcnt vmcnt(4)
L_nt_13:
    s_add_u32 s46, s64, 0x30000
    buffer_load_dwordx4 v[104:107], v2, s[4:7], s46 offen offset:2048 nt
    s_waitcnt vmcnt(5)
    s_cmp_eq_u32 s65, 0
    s_cbranch_scc1 L_nt_14
    s_waitcnt vmcnt(4)
L_nt_14:
    s_add_u32 s46, s64, 0x30000
    buffer_load_dwordx4 v[108:111], v2, s[4:7], s46 offen offset:3072 nt
    s_waitcnt vmcnt(5)
    s_cmp_eq_u32 s65, 0
    s_cbranch_scc1 L_nt_15
    s_waitcnt vmcnt(4)
L_nt_15:
    s_add_u32 s46, s64, 0x40000
    buffer_load_dwordx4 v[112:115], v2, s[4:7], s46 offen offset:0 nt
    s_waitcnt vmcnt(5)
    s_cmp_eq_u32 s65, 0
    s_cbranch_scc1 L_nt_16
    s_waitcnt vmcnt(3)
L_nt_16:
    s_add_u32 s46, s64, 0x40000
    buffer_load_dwordx4 v[116:119], v2, s[4:7], s46 offen offset:1024 nt
    s_waitcnt vmcnt(4)
    s_cmp_eq_u32 s65, 0
    s_cbranch_scc1 L_nt_17
    s_waitcnt vmcnt(3)
L_nt_17:
    s_add_u32 s46, s64, 0x40000
    buffer_load_dwordx4 v[120:123], v2, s[4:7], s46 offen offset:2048 nt
    v_cmp_ne_u32 vcc, s78, v250
    s_cmp_eq_u64 vcc, 0
    s_cselect_b32 s3, 1, 0
    s_waitcnt vmcnt(4)
    s_cmp_eq_u32 s65, 0
    s_cbranch_scc1 L_nt_18
    s_waitcnt vmcnt(3)
L_nt_18:
    s_add_u32 s46, s64, 0x40000
    buffer_load_dwordx4 v[124:127], v2, s[4:7], s46 offen offset:3072 nt
    s_waitcnt vmcnt(4)
    s_cmp_eq_u32 s65, 0
    s_cbranch_scc1 L_nt_19
    s_waitcnt vmcnt(3)
L_nt_19:
    s_add_u32 s46, s64, 0x50000
    buffer_load_dwordx4 v[128:131], v2, s[4:7], s46 offen offset:0 nt
    s_branch L_common
L_role_Q:
    s_waitcnt lgkmcnt(0)
    s_load_dword s40, s[12:13], 0
    s_mov_b64 s[24:25], s[64:65]
    s_mov_b64 s[16:17], s[72:73]
    s_mov_b64 s[20:21], s[70:71]
    v_lshrrev_b32 v5, 6, v0
    v_and_b32 v1, 63, v0
    s_nop 0
    v_readfirstlane_b32 s44, v5
    v_lshlrev_b32 v0, 4, v1
    s_mov_b32 s26, 0x2400
    s_mov_b32 s27, 0x20000
    s_mov_b32 s18, 0x480000
    s_mov_b32 s19, 0x20000
    s_cmp_ge_u32 s49, 26
    s_cselect_b32 s59, 2, 0
    s_cselect_b32 s52, 3, s49
    s_cmp_eq_u32 s49, 29
    s_cselect_b32 s52, 7, s52
    s_lshl3_add_u32 s52, s48, s52
    s_mov_b32 s22, 0x480000
    s_mov_b32 s23, 0x20000
    s_and_b32 s46, s52, 7
    s_cmp_eq_u32 s46, 3
    s_cselect_b32 s46, 1, 0
    s_max_u32 s59, s59, s46
    s_cmp_eq_u32 s52, 63
    s_cselect_b32 s46, 1, 0
    s_max_u32 s59, s59, s46
    s_lshl_b32 s52, s52, 7
    v_lshrrev_b32 v6, 3, v1
    v_and_b32 v7, 7, v1
    v_mul_u32_u24 v14, 8192, v6
    v_lshlrev_b32 v3, 3, v14
    v_lshl_add_u32 v3, v7, 4, v3
    v_lshl_add_u32 v14, v7, 4, v14
    s_mul_i32 s53, s44, 589824
    s_add_u32 s53, s53, s52
    v_mul_u32_u24 v15, 1152, v7
    v_lshl_add_u32 v4, v6, 4, v15
    v_lshl_add_u32 v15, v6, 1, v15
    s_mul_i32 s50, s44, 144
    v_and_b32 v16, 1, v6
    v_sub_u32 v16, 2, v16
    v_cmp_eq_u32 vcc, s59, v16
    v_bfrev_b32 v16, 2
    s_nop 0
    v_cndmask_b32 v3, v3, v16, vcc
    v_cndmask_b32 v14, v14, v16, vcc
    buffer_load_dwordx4 v[8:11], v4, s[24:27], s50 offen
    buffer_load_ushort v12, v15, s[24:27], s50 offen offset:128
    buffer_load_dwordx4 v[176:179], v3, s[20:23], s53 offen nt
    s_add_u32 s53, s53, 8192
    buffer_load_dwordx4 v[180:183], v3, s[20:23], s53 offen nt
    s_add_u32 s53, s53, 8192
    buffer_load_dwordx4 v[184:187], v3, s[20:23], s53 offen nt
    s_add_u32 s53, s53, 8192
    buffer_load_dwordx4 v[188:191], v3, s[20:23], s53 offen nt
    s_add_u32 s53, s53, 8192
    s_mov_b64 s[4:5], s[66:67]
    s_mov_b64 s[8:9], s[68:69]
    s_barrier
    s_mov_b32 s10, 0x10000000
    s_mov_b32 s11, 0x20000
    s_mov_b32 s14, 0x168000
    s_mov_b32 s15, 0x20000
    s_and_b32 s60, s2, 7
    s_bfe_u32 s61, s2, 0x10004
    s_lshl1_add_u32 s60, s60, s61
    s_lshr_b32 s61, s2, 5
    s_bfe_u32 s62, s2, 0x10003
    s_lshl4_add_u32 s63, s61, s60
    s_lshl_b32 s64, s63, 21
    s_add_u32 s64, s64, 0x180000
    s_lshl_b32 s63, s63, 1
    s_lshl_b32 s46, s62, 12
    s_add_u32 s64, s64, s46
    s_bfe_u32 s46, s44, 0x10000
    s_lshl_b32 s46, s46, 13
    s_add_u32 s64, s64, s46
    s_bfe_u32 s46, s44, 0x10001
    s_lshl_b32 s46, s46, 14
    s_add_u32 s64, s64, s46
    s_bfe_u32 s46, s44, 0x10002
    s_lshl_b32 s46, s46, 15
    s_add_u32 s64, s64, s46
    v_bfe_u32 v2, v1, 2, 1
    v_lshlrev_b32 v2, 8, v2
    v_bfe_u32 v5, v1, 3, 1
    v_lshl_add_u32 v2, v5, 9, v2
    v_lshrrev_b32 v5, 4, v1
    v_lshl_add_u32 v2, v5, 6, v2
    v_and_b32 v5, 3, v1
    v_lshl_add_u32 v2, v5, 4, v2
    s_mov_b32 s6, 0x10000000
    s_mov_b32 s7, 0x20000
    s_and_b32 s46, s64, 0xfff80000
    s_cmp_eq_u32 s44, 1
    s_cselect_b32 s46, s46, 0x40000000
    s_mul_i32 s47, s60, 294912
    s_cmp_eq_u32 s44, 1
    s_cselect_b32 s47, s47, 0x40000000
    v_mul_u32_u24 v250, 524288, v1
    v_mul_u32_u24 v248, 294912, v1
    s_mov_b64 exec, 0x1
    buffer_load_dword v251, v250, s[4:7], s46 offen nt
    buffer_load_dword v251, v250, s[8:11], s46 offen nt
    buffer_load_dword v251, v248, s[16:19], s47 offen
    s_mov_b64 exec, -1
    s_mov_b32 s101, 0
    s_and_b32 s55, s2, 7
    s_lshr_b32 s56, s2, 3
    s_cmp_ge_u32 s56, 14
    s_cselect_b32 s54, 1, 0
    s_cmp_eq_u32 s44, 7
    s_cselect_b32 s54, s54, 0
    s_sub_u32 s56, s56, 14
    s_mov_b32 s65, 0
    s_lshl_b32 s45, s52, 1
    s_add_u32 s45, s45, 4096
    s_mul_i32 s46, s44, 16640
    s_add_u32 s45, s45, s46
    s_lshr_b32 s58, s52, 10
    s_cmpk_eq_u32 s52, 8064
    s_cselect_b32 s58, 20, s58
    s_lshl_b32 s58, s58, 11
    s_lshl_b32 s46, s44, 8
    s_add_u32 s58, s58, s46
    s_add_u32 s58, s58, 360448
    s_getreg_b32 s47, hwreg(HW_REG_XCC_ID)
    s_and_b32 s47, s47, 15
    s_lshr_b32 s65, 0x55, s47
    s_and_b32 s65, s65, 1
    s_lshl_b32 s79, s55, 7
    s_lshr_b32 s46, s2, 3
    s_lshl_b32 s46, s46, 2
    s_add_u32 s46, s46, s79
    s_cmp_eq_u32 s44, 0
    s_cselect_b32 s46, s46, 0x40000000
    v_and_b32 v249, 31, v1
    v_lshlrev_b32 v249, 2, v249
    s_waitcnt lgkmcnt(0)
    s_add_u32 s40, s40, 0x01010101
    s_andn2_b32 s78, s40, 15
    s_or_b32 s78, s78, s47
    v_mov_b32 v248, s78
    s_mov_b64 exec, 1
    buffer_store_dword v248, v249, s[12:15], s46 offen offset:1024
    s_mov_b64 exec, -1
    s_lshr_b32 s41, s40, 8
    s_lshl_b32 s46, s40, 24
    s_or_b32 s41, s41, s46
    s_lshr_b32 s42, s40, 16
    s_lshl_b32 s46, s40, 16
    s_or_b32 s42, s42, s46
    s_lshr_b32 s43, s40, 24
    s_lshl_b32 s46, s40, 8
    s_or_b32 s43, s43, s46
    s_and_b32 s28, s40, 0xff
    s_and_b32 s29, s41, 0xff
    s_and_b32 s30, s42, 0xff
    s_and_b32 s31, s43, 0xff
    s_waitcnt vmcnt(9)
    buffer_load_dwordx4 v[192:195], v3, s[20:23], s53 offen nt
    s_add_u32 s53, s53, 8192
    s_waitcnt vmcnt(8)
    buffer_load_dwordx4 v[196:199], v3, s[20:23], s53 offen nt
    s_add_u32 s53, s53, 8192
    s_mov_b32 s48, 0x05040100
    s_mov_b32 s49, 0x07060302
    v_mov_b32 v212, 0
    v_mov_b32 v213, 0
    v_mov_b32 v214, v12
    v_mov_b32 v215, 0
    v_mov_b32 v216, 0
    v_mov_b32 v217, 0
    v_mov_b32 v218, 0
    v_mov_b32 v219, v12
    v_mov_b32 v220, 0
    v_mov_b32 v221, 0
    v_lshlrev_b32 v222, 16, v12
    v_mov_b32 v223, 0
    v_mov_b32 v224, 0
    v_mov_b32 v225, 0
    v_mov_b32 v226, 0
    v_lshlrev_b32 v227, 16, v12
    v_mov_b32 v228, 0
    v_mov_b32 v229, 0
    s_waitcnt vmcnt(8)
    buffer_load_dwordx4 v[200:203], v3, s[20:23], s53 offen nt
    s_add_u32 s53, s53, 8192
    s_waitcnt vmcnt(8)
    buffer_load_dwordx4 v[204:207], v3, s[20:23], s53 offen nt
    s_add_u32 s53, s53, 466944
    s_waitcnt vmcnt(8)
    buffer_load_dwordx4 v[208:211], v14, s[20:23], s53 offen nt
    s_waitcnt vmcnt(4)
    buffer_load_dwordx4 v[48:51], v2, s[4:7], s64 offen offset:0 nt
    buffer_load_dword v250, v249, s[12:15], s79 offen offset:1024 sc1
    s_waitcnt vmcnt(5)
    buffer_load_dwordx4 v[52:55], v2, s[4:7], s64 offen offset:1024 nt
    s_waitcnt vmcnt(5)
    s_cmp_eq_u32 s65, 0
    s_cbranch_scc1 L_nt_20
    s_waitcnt vmcnt(4)
L_nt_20:
    buffer_load_dwordx4 v[56:59], v2, s[4:7], s64 offen offset:2048 nt
    s_waitcnt vmcnt(5)
    s_cmp_eq_u32 s65, 0
    s_cbranch_scc1 L_nt_21
    s_waitcnt vmcnt(4)
L_nt_21:
    buffer_load_dwordx4 v[60:63], v2, s[4:7], s64 offen offset:3072 nt
    s_waitcnt vmcnt(5)
    s_cmp_eq_u32 s65, 0
    s_cbranch_scc1 L_nt_22
    s_waitcnt vmcnt(4)
L_nt_22:
    s_add_u32 s46, s64, 0x10000
    buffer_load_dwordx4 v[64:67], v2, s[4:7], s46 offen offset:0 nt
    v_perm_b32 v232, v180, v176, s48
    v_perm_b32 v233, v188, v184, s48
    v_perm_b32 v234, v196, v192, s48
    v_perm_b32 v235, v204, v200, s48
    v_mfma_f32_16x16x32_bf16 v[16:19], v[208:211], v[214:217], 0
    s_nop 0
    v_mfma_f32_16x16x32_bf16 v[16:19], v[232:235], v[8:11], v[16:19]
    v_perm_b32 v236, v180, v176, s49
    v_perm_b32 v237, v188, v184, s49
    v_perm_b32 v238, v196, v192, s49
    v_perm_b32 v239, v204, v200, s49
    v_mfma_f32_16x16x32_bf16 v[20:23], v[208:211], v[222:225], 0
    s_nop 0
    v_mfma_f32_16x16x32_bf16 v[20:23], v[236:239], v[8:11], v[20:23]
    v_perm_b32 v240, v181, v177, s48
    v_perm_b32 v241, v189, v185, s48
    v_perm_b32 v242, v197, v193, s48
    v_perm_b32 v243, v205, v201, s48
    v_mfma_f32_16x16x32_bf16 v[24:27], v[208:211], v[218:221], 0
    s_nop 0
    v_mfma_f32_16x16x32_bf16 v[24:27], v[240:243], v[8:11], v[24:27]
    v_perm_b32 v244, v181, v177, s49
    v_perm_b32 v245, v189, v185, s49
    v_perm_b32 v246, v197, v193, s49
    v_perm_b32 v247, v205, v201, s49
    v_mfma_f32_16x16x32_bf16 v[28:31], v[208:211], v[226:229], 0
    s_nop 0
    v_mfma_f32_16x16x32_bf16 v[28:31], v[244:247], v[8:11], v[28:31]
    v_perm_b32 v232, v182, v178, s48
    v_perm_b32 v233, v190, v186, s48
    v_perm_b32 v234, v198, v194, s48
    v_perm_b32 v235, v206, v202, s48
    v_mfma_f32_16x16x32_bf16 v[32:35], v[208:211], v[212:215], 0
    s_nop 0
    v_mfma_f32_16x16x32_bf16 v[32:35], v[232:235], v[8:11], v[32:35]
    v_perm_b32 v236, v182, v178, s49
    v_perm_b32 v237, v190, v186, s49
    v_perm_b32 v238, v198, v194, s49
    v_perm_b32 v239, v206, v202, s49
    v_mfma_f32_16x16x32_bf16 v[36:39], v[208:211], v[220:223], 0
    s_nop 0
    v_mfma_f32_16x16x32_bf16 v[36:39], v[236:239], v[8:11], v[36:39]
    v_perm_b32 v240, v183, v179, s48
    v_perm_b32 v241, v191, v187, s48
    v_perm_b32 v242, v199, v195, s48
    v_perm_b32 v243, v207, v203, s48
    v_mfma_f32_16x16x32_bf16 v[40:43], v[208:211], v[216:219], 0
    s_nop 0
    v_mfma_f32_16x16x32_bf16 v[40:43], v[240:243], v[8:11], v[40:43]
    v_perm_b32 v244, v183, v179, s49
    v_perm_b32 v245, v191, v187, s49
    v_perm_b32 v246, v199, v195, s49
    v_perm_b32 v247, v207, v203, s49
    v_mfma_f32_16x16x32_bf16 v[44:47], v[208:211], v[224:227], 0
    s_nop 0
    v_mfma_f32_16x16x32_bf16 v[44:47], v[244:247], v[8:11], v[44:47]
    v_lshrrev_b32 v5, 5, v1
    v_mul_u32_u24 v5, 2176, v5
    v_and_b32 v8, 7, v1
    v_mul_u32_u24 v8, 272, v8
    v_add_u32 v5, v5, v8
    v_and_b32 v8, 16, v1
    s_mul_i32 s46, s44, 4352
    v_add3_u32 v5, v5, v8, s46
    s_mov_b32 exec_lo, 0x00ff00ff
    s_mov_b32 exec_hi, 0xff00ff00
    ds_write_b128 v5, v[16:19] offset:0
    ds_write_b128 v5, v[20:23] offset:32
    ds_write_b128 v5, v[24:27] offset:64
    ds_write_b128 v5, v[28:31] offset:96
    ds_write_b128 v5, v[32:35] offset:128
    ds_write_b128 v5, v[36:39] offset:160
    ds_write_b128 v5, v[40:43] offset:192
    ds_write_b128 v5, v[44:47] offset:224
    s_mov_b64 exec, 1
    v_mov_b32 v8, 0
    v_mov_b32 v9, 1
    ds_add_u32 v8, v9 offset:47300
    s_mov_b64 exec, -1
    s_waitcnt vmcnt(5)
    s_cmp_eq_u32 s65, 0
    s_cbranch_scc1 L_nt_23
    s_waitcnt vmcnt(3)
L_nt_23:
    s_add_u32 s46, s64, 0x10000
    buffer_load_dwordx4 v[68:71], v2, s[4:7], s46 offen offset:1024 nt
    s_waitcnt vmcnt(4)
    s_cmp_eq_u32 s65, 0
    s_cbranch_scc1 L_nt_24
    s_waitcnt vmcnt(3)
L_nt_24:
    s_add_u32 s46, s64, 0x10000
    buffer_load_dwordx4 v[72:75], v2, s[4:7], s46 offen offset:2048 nt
    v_cmp_ne_u32 vcc, s78, v250
    s_cmp_eq_u64 vcc, 0
    s_cselect_b32 s3, 1, 0
    v_lshlrev_b32 v5, 5, v7
    v_lshl_add_u32 v5, v6, 2, v5
    s_mul_i32 s46, s44, 272
    v_add_u32 v5, s46, v5
    v_and_b32 v11, 3, v1
    v_lshlrev_b32 v11, 3, v11
    v_mov_b32 v12, s40
    v_alignbit_b32 v11, v12, v12, v11
    s_mov_b32 s47, 32000000
    v_mov_b32 v9, 0
L_uc_top_25:
    ds_read_b32 v8, v9 offset:47300
    s_waitcnt lgkmcnt(0)
    v_readfirstlane_b32 s46, v8
    s_sub_u32 s47, s47, 1
    s_cbranch_scc1 L_uc_ok_26
    s_cmp_lt_u32 s46, 8
    s_cbranch_scc1 L_uc_top_25
L_uc_ok_26:
    ds_read_b32 v16, v5 offset:0
    ds_read_b32 v17, v5 offset:2176
    ds_read_b32 v18, v5 offset:4352
    ds_read_b32 v19, v5 offset:6528
    ds_read_b32 v20, v5 offset:8704
    ds_read_b32 v21, v5 offset:10880
    ds_read_b32 v22, v5 offset:13056
    ds_read_b32 v23, v5 offset:15232
    ds_read_b32 v24, v5 offset:17408
    ds_read_b32 v25, v5 offset:19584
    ds_read_b32 v26, v5 offset:21760
    ds_read_b32 v27, v5 offset:23936
    ds_read_b32 v28, v5 offset:26112
    ds_read_b32 v29, v5 offset:28288
    ds_read_b32 v30, v5 offset:30464
    ds_read_b32 v31, v5 offset:32640
    v_lshlrev_b32 v9, 2, v1
    v_mov_b32 v10, v9
    s_waitcnt lgkmcnt(0)
    v_add_f32 v16, v16, v24
    v_add_f32 v17, v17, v25
    v_add_f32 v18, v18, v26
    v_add_f32 v19, v19, v27
    v_add_f32 v20, v20, v28
    v_add_f32 v21, v21, v29
    v_add_f32 v22, v22, v30
    v_add_f32 v23, v23, v31
    v_add_f32 v16, v16, v20
    v_add_f32 v17, v17, v21
    v_add_f32 v18, v18, v22
    v_add_f32 v19, v19, v23
    v_add_f32 v16, v16, v18
    v_add_f32 v17, v17, v19
    v_add_f32 v16, v16, v17
    s_mov_b32 s50, s45
    v_mov_b32 v8, v10
    s_cmp_eq_u32 s59, 0
    s_cbranch_scc1 L_unrm_27
    s_mov_b32 s50, s58
    s_cmp_eq_u32 s59, 2
    s_cselect_b32 s50, s50, 0x40000000
    s_movk_i32 s49, 0xff
    v_mov_b32 v8, v9
    v_bfi_b32 v14, s49, v11, v16
    s_branch L_udn_28
L_unrm_27:
    v_cvt_pk_bf16_f32 v16, v16, v16
    s_mov_b32 s49, 0xffff
    v_bfi_b32 v14, s49, v11, v16
L_udn_28:
    s_cmp_eq_u32 s3, 1
    s_cbranch_scc1 L_stl_29
    buffer_store_dword v14, v8, s[12:15], s50 offen sc1
    s_branch L_std_30
L_stl_29:
    buffer_store_dword v14, v8, s[12:15], s50 offen
L_std_30:
    s_cmp_eq_u32 s59, 1
    s_cselect_b32 s58, s58, 0x40000000
    s_cmp_eq_u32 s59, 1
    s_cselect_b32 s45, s45, 0x40000000
    s_waitcnt vmcnt(5)
    s_cmp_eq_u32 s65, 0
    s_cbranch_scc1 L_nt_31
    s_waitcnt vmcnt(4)
L_nt_31:
    s_add_u32 s46, s64, 0x10000
    buffer_load_dwordx4 v[76:79], v2, s[4:7], s46 offen offset:3072 nt
    s_waitcnt vmcnt(5)
    s_cmp_eq_u32 s65, 0
    s_cbranch_scc1 L_nt_32
    s_waitcnt vmcnt(4)
L_nt_32:
    s_add_u32 s46, s64, 0x20000
    buffer_load_dwordx4 v[80:83], v2, s[4:7], s46 offen offset:0 nt
    s_waitcnt vmcnt(5)
    s_cmp_eq_u32 s65, 0
    s_cbranch_scc1 L_nt_33
    s_waitcnt vmcnt(4)
L_nt_33:
    s_add_u32 s46, s64, 0x20000
    buffer_load_dwordx4 v[84:87], v2, s[4:7], s46 offen offset:1024 nt
    s_waitcnt vmcnt(5)
    s_cmp_eq_u32 s65, 0
    s_cbranch_scc1 L_nt_34
    s_waitcnt vmcnt(4)
L_nt_34:
    s_add_u32 s46, s64, 0x20000
    buffer_load_dwordx4 v[88:91], v2, s[4:7], s46 offen offset:2048 nt
    s_waitcnt vmcnt(5)
    s_cmp_eq_u32 s65, 0
    s_cbranch_scc1 L_nt_35
    s_waitcnt vmcnt(3)
L_nt_35:
    s_add_u32 s46, s64, 0x20000
    buffer_load_dwordx4 v[92:95], v2, s[4:7], s46 offen offset:3072 nt
    s_waitcnt vmcnt(4)
    s_cmp_eq_u32 s65, 0
    s_cbranch_scc1 L_nt_36
    s_waitcnt vmcnt(3)
L_nt_36:
    s_add_u32 s46, s64, 0x30000
    buffer_load_dwordx4 v[96:99], v2, s[4:7], s46 offen offset:0 nt
    buffer_load_dword v17, v9, s[12:15], s58 offen sc1
    buffer_load_dword v250, v249, s[12:15], s79 offen offset:1024 sc1
    s_waitcnt vmcnt(6)
    s_cmp_eq_u32 s65, 0
    s_cbranch_scc1 L_nt_37
    s_waitcnt vmcnt(5)
L_nt_37:
    s_add_u32 s46, s64, 0x30000
    buffer_load_dwordx4 v[100:103], v2, s[4:7], s46 offen offset:1024 nt
    s_waitcnt vmcnt(6)
    s_cmp_eq_u32 s65, 0
    s_cbranch_scc1 L_nt_38
    s_waitcnt vmcnt(5)
L_nt_38:
    s_add_u32 s46, s64, 0x30000
    buffer_load_dwordx4 v[104:107], v2, s[4:7], s46 offen offset:2048 nt
    s_waitcnt vmcnt(6)
    s_cmp_eq_u32 s65, 0
    s_cbranch_scc1 L_nt_39
    s_waitcnt vmcnt(5)
L_nt_39:
    s_add_u32 s46, s64, 0x30000
    buffer_load_dwordx4 v[108:111], v2, s[4:7], s46 offen offset:3072 nt
    s_waitcnt vmcnt(6)
    s_cmp_eq_u32 s65, 0
    s_cbranch_scc1 L_nt_40
    s_waitcnt vmcnt(5)
L_nt_40:
    s_add_u32 s46, s64, 0x40000
    buffer_load_dwordx4 v[112:115], v2, s[4:7], s46 offen offset:0 nt
    s_waitcnt vmcnt(6)
    s_cmp_eq_u32 s65, 0
    s_cbranch_scc1 L_nt_41
    s_waitcnt vmcnt(3)
L_nt_41:
    s_add_u32 s46, s64, 0x40000
    buffer_load_dwordx4 v[116:119], v2, s[4:7], s46 offen offset:1024 nt
    s_waitcnt vmcnt(4)
    s_cmp_eq_u32 s65, 0
    s_cbranch_scc1 L_nt_42
    s_waitcnt vmcnt(3)
L_nt_42:
    s_add_u32 s46, s64, 0x40000
    buffer_load_dwordx4 v[120:123], v2, s[4:7], s46 offen offset:2048 nt
    v_cmp_ne_u32 vcc, s78, v250
    s_cmp_eq_u64 vcc, 0
    s_cselect_b32 s3, 1, 0
    s_cmp_lg_u32 s59, 1
    s_cbranch_scc1 L_nomain_43
    s_mov_b32 s47, 2000000
L_hf_top_44:
    v_xor_b32 v18, v17, v11
    v_and_b32 v18, 0xff, v18
    v_cmp_ne_u32 vcc, 0, v18
    s_sub_u32 s47, s47, 1
    s_cbranch_scc1 L_hf_ok_45
    s_nop 2
    s_cbranch_vccz L_hf_ok_45
    buffer_load_dword v17, v9, s[12:15], s58 offen sc1
    s_waitcnt vmcnt(0)
    s_branch L_hf_top_44
L_hf_ok_45:
    v_and_b32 v17, 0xffffff00, v17
    v_add_f32 v16, v16, v17
    v_cvt_pk_bf16_f32 v16, v16, v16
    s_mov_b32 s49, 0xffff
    v_bfi_b32 v14, s49, v11, v16
L_nomain_43:
    s_cmp_eq_u32 s3, 1
    s_cbranch_scc1 L_stl_46
    buffer_store_dword v14, v10, s[12:15], s45 offen sc1
    s_branch L_std_47
L_stl_46:
    buffer_store_dword v14, v10, s[12:15], s45 offen
L_std_47:
    s_waitcnt vmcnt(5)
    s_cmp_eq_u32 s65, 0
    s_cbranch_scc1 L_nt_48
    s_waitcnt vmcnt(4)
L_nt_48:
    s_add_u32 s46, s64, 0x40000
    buffer_load_dwordx4 v[124:127], v2, s[4:7], s46 offen offset:3072 nt
    s_waitcnt vmcnt(5)
    s_cmp_eq_u32 s65, 0
    s_cbranch_scc1 L_nt_49
    s_waitcnt vmcnt(4)
L_nt_49:
    s_add_u32 s46, s64, 0x50000
    buffer_load_dwordx4 v[128:131], v2, s[4:7], s46 offen offset:0 nt
    s_branch L_common
L_role_H:
    s_waitcnt lgkmcnt(0)
    s_load_dword s40, s[12:13], 0
    s_mov_b64 s[24:25], s[64:65]
    s_mov_b64 s[16:17], s[72:73]
    s_mov_b64 s[20:21], s[76:77]
    s_mov_b64 s[36:37], s[78:79]
    v_lshrrev_b32 v5, 6, v0
    v_and_b32 v1, 63, v0
    s_nop 0
    v_readfirstlane_b32 s44, v5
    v_lshlrev_b32 v0, 4, v1
    s_mov_b32 s26, 0x2400
    s_mov_b32 s27, 0x20000
    s_mov_b32 s18, 0x480000
    s_mov_b32 s19, 0x20000
    s_cmp_ge_u32 s49, 26
    s_cselect_b32 s59, 2, 0
    s_add_u32 s52, s48, s49
    s_sub_u32 s52, s52, 8
    s_cmp_gt_u32 s48, 3
    s_cselect_b32 s46, 11, 3
    s_cmp_eq_u32 s49, 29
    s_cselect_b32 s46, 11, s46
    s_cmp_eq_u32 s59, 2
    s_cselect_b32 s52, s46, s52
    s_lshl3_add_u32 s52, s48, s52
    s_mov_b32 s22, 0x510000
    s_mov_b32 s23, 0x20000
    s_mov_b32 s38, 0x2400
    s_mov_b32 s39, 0x20000
    s_and_b32 s46, s52, 7
    s_cmp_eq_u32 s46, 3
    s_cselect_b32 s46, 1, 0
    s_max_u32 s59, s59, s46
    s_lshl_b32 s52, s52, 7
    v_lshrrev_b32 v6, 3, v1
    v_and_b32 v7, 7, v1
    v_mul_u32_u24 v14, 9216, v6
    v_lshlrev_b32 v3, 3, v14
    v_lshl_add_u32 v3, v7, 4, v3
    v_lshl_add_u32 v14, v7, 4, v14
    s_mul_i32 s53, s44, 663552
    s_add_u32 s53, s53, s52
    v_mul_u32_u24 v15, 1152, v7
    v_lshl_add_u32 v4, v6, 4, v15
    v_lshl_add_u32 v15, v6, 1, v15
    s_mul_i32 s50, s44, 144
    v_and_b32 v16, 1, v6
    v_sub_u32 v16, 2, v16
    v_cmp_eq_u32 vcc, s59, v16
    v_bfrev_b32 v16, 2
    s_nop 0
    v_cndmask_b32 v3, v3, v16, vcc
    v_cndmask_b32 v14, v14, v16, vcc
    buffer_load_dwordx4 v[8:11], v4, s[24:27], s50 offen
    buffer_load_ushort v12, v15, s[24:27], s50 offen offset:128
    buffer_load_dwordx4 v[176:179], v3, s[20:23], s53 offen nt
    s_add_u32 s53, s53, 9216
    buffer_load_dwordx4 v[180:183], v3, s[20:23], s53 offen nt
    s_add_u32 s53, s53, 9216
    buffer_load_dwordx4 v[184:187], v3, s[20:23], s53 offen nt
    s_add_u32 s53, s53, 9216
    buffer_load_dwordx4 v[188:191], v3, s[20:23], s53 offen nt
    s_add_u32 s53, s53, 9216
    s_mov_b64 s[4:5], s[66:67]
    s_mov_b64 s[8:9], s[68:69]
    s_barrier
    s_mov_b32 s10, 0x10000000
    s_mov_b32 s11, 0x20000
    s_mov_b32 s14, 0x168000
    s_mov_b32 s15, 0x20000
    s_and_b32 s60, s2, 7
    s_bfe_u32 s61, s2, 0x10004
    s_lshl1_add_u32 s60, s60, s61
    s_lshr_b32 s61, s2, 5
    s_bfe_u32 s62, s2, 0x10003
    s_lshl4_add_u32 s63, s61, s60
    s_lshl_b32 s64, s63, 21
    s_add_u32 s64, s64, 0x180000
    s_lshl_b32 s63, s63, 1
    s_lshl_b32 s46, s62, 12
    s_add_u32 s64, s64, s46
    s_bfe_u32 s46, s44, 0x10000
    s_lshl_b32 s46, s46, 13
    s_add_u32 s64, s64, s46
    s_bfe_u32 s46, s44, 0x10001
    s_lshl_b32 s46, s46, 14
    s_add_u32 s64, s64, s46
    s_bfe_u32 s46, s44, 0x10002
    s_lshl_b32 s46, s46, 15
    s_add_u32 s64, s64, s46
    v_bfe_u32 v2, v1, 2, 1
    v_lshlrev_b32 v2, 8, v2
    v_bfe_u32 v5, v1, 3, 1
    v_lshl_add_u32 v2, v5, 9, v2
    v_lshrrev_b32 v5, 4, v1
    v_lshl_add_u32 v2, v5, 6, v2
    v_and_b32 v5, 3, v1
    v_lshl_add_u32 v2, v5, 4, v2
    s_mov_b32 s6, 0x10000000
    s_mov_b32 s7, 0x20000
    s_and_b32 s46, s64, 0xfff80000
    s_cmp_eq_u32 s44, 1
    s_cselect_b32 s46, s46, 0x40000000
    s_mul_i32 s47, s60, 294912
    s_cmp_eq_u32 s44, 1
    s_cselect_b32 s47, s47, 0x40000000
    v_mul_u32_u24 v250, 524288, v1
    v_mul_u32_u24 v248, 294912, v1
    s_mov_b64 exec, 0x1
    buffer_load_dword v251, v250, s[4:7], s46 offen nt
    buffer_load_dword v251, v250, s[8:11], s46 offen nt
    buffer_load_dword v251, v248, s[16:19], s47 offen
    s_mov_b64 exec, -1
    s_mov_b32 s101, 0
    s_and_b32 s55, s2, 7
    s_lshr_b32 s56, s2, 3
    s_cmp_ge_u32 s56, 14
    s_cselect_b32 s54, 1, 0
    s_cmp_eq_u32 s44, 7
    s_cselect_b32 s54, s54, 0
    s_sub_u32 s56, s56, 14
    s_mov_b32 s65, 0
    s_lshr_b32 s45, s52, 4
    s_add_u32 s45, s45, s44
    s_mul_i32 s46, s45, 7282
    s_lshr_b32 s46, s46, 16
    s_mul_i32 s47, s46, 9
    s_sub_u32 s51, s45, s47
    s_mul_i32 s45, s46, 2304
    s_lshl_b32 s47, s51, 7
    s_cmp_eq_u32 s51, 8
    s_cselect_b32 s47, 0x800, s47
    s_add_u32 s45, s45, s47
    s_add_u32 s45, s45, 196608
    s_lshr_b32 s58, s52, 10
    s_lshl_b32 s58, s58, 11
    s_lshl_b32 s46, s44, 8
    s_add_u32 s58, s58, s46
    s_add_u32 s58, s58, 376832
    s_getreg_b32 s47, hwreg(HW_REG_XCC_ID)
    s_and_b32 s47, s47, 15
    s_lshr_b32 s65, 0x55, s47
    s_and_b32 s65, s65, 1
    s_lshl_b32 s79, s55, 7
    s_lshr_b32 s46, s2, 3
    s_lshl_b32 s46, s46, 2
    s_add_u32 s46, s46, s79
    s_cmp_eq_u32 s44, 0
    s_cselect_b32 s46, s46, 0x40000000
    v_and_b32 v249, 31, v1
    v_lshlrev_b32 v249, 2, v249
    s_waitcnt lgkmcnt(0)
    s_add_u32 s40, s40, 0x01010101
    s_andn2_b32 s78, s40, 15
    s_or_b32 s78, s78, s47
    v_mov_b32 v248, s78
    s_mov_b64 exec, 1
    buffer_store_dword v248, v249, s[12:15], s46 offen offset:1024
    s_mov_b64 exec, -1
    s_lshr_b32 s41, s40, 8
    s_lshl_b32 s46, s40, 24
    s_or_b32 s41, s41, s46
    s_lshr_b32 s42, s40, 16
    s_lshl_b32 s46, s40, 16
    s_or_b32 s42, s42, s46
    s_lshr_b32 s43, s40, 24
    s_lshl_b32 s46, s40, 8
    s_or_b32 s43, s43, s46
    s_and_b32 s28, s40, 0xff
    s_and_b32 s29, s41, 0xff
    s_and_b32 s30, s42, 0xff
    s_and_b32 s31, s43, 0xff
    s_waitcnt vmcnt(9)
    buffer_load_dwordx4 v[192:195], v3, s[20:23], s53 offen nt
    s_add_u32 s53, s53, 9216
    s_waitcnt vmcnt(8)
    buffer_load_dwordx4 v[196:199], v3, s[20:23], s53 offen nt
    s_add_u32 s53, s53, 9216
    v_lshlrev_b32 v16, 16, v8
    v_and_b32 v17, 0xffff0000, v8
    v_lshlrev_b32 v18, 16, v9
    v_and_b32 v19, 0xffff0000, v9
    v_lshlrev_b32 v20, 16, v10
    v_and_b32 v21, 0xffff0000, v10
    v_lshlrev_b32 v22, 16, v11
    v_and_b32 v23, 0xffff0000, v11
    v_lshlrev_b32 v24, 16, v12
    v_add_f32 v40, v16, v17
    v_add_f32 v40, v40, v18
    v_add_f32 v40, v40, v19
    v_add_f32 v40, v40, v20
    v_add_f32 v40, v40, v21
    v_add_f32 v40, v40, v22
    v_add_f32 v40, v40, v23
    v_add_f32 v40, v40, v24
    s_nop 1
    v_add_f32_dpp v40, v40, v40 row_ror:8 row_mask:0xf bank_mask:0xf
    v_mov_b32 v42, v40
    s_nop 1
    v_permlane16_swap_b32 v42, v40
    s_nop 0
    v_add_f32 v40, v40, v42
    v_mov_b32 v42, v40
    s_nop 1
    v_permlane32_swap_b32 v42, v40
    s_nop 0
    v_add_f32 v40, v40, v42
    v_mul_f32 v40, 0x3c638e39, v40
    v_sub_f32 v42, v16, v40
    v_mul_f32 v41, v42, v42
    v_sub_f32 v42, v17, v40
    v_fmac_f32 v41, v42, v42
    v_sub_f32 v42, v18, v40
    v_fmac_f32 v41, v42, v42
    v_sub_f32 v42, v19, v40
    v_fmac_f32 v41, v42, v42
    v_sub_f32 v42, v20, v40
    v_fmac_f32 v41, v42, v42
    v_sub_f32 v42, v21, v40
    v_fmac_f32 v41, v42, v42
    v_sub_f32 v42, v22, v40
    v_fmac_f32 v41, v42, v42
    v_sub_f32 v42, v23, v40
    v_fmac_f32 v41, v42, v42
    v_sub_f32 v42, v24, v40
    v_fmac_f32 v41, v42, v42
    s_nop 1
    v_add_f32_dpp v41, v41, v41 row_ror:8 row_mask:0xf bank_mask:0xf
    v_mov_b32 v42, v41
    s_nop 1
    v_permlane16_swap_b32 v42, v41
    s_nop 0
    v_add_f32 v41, v41, v42
    v_mov_b32 v42, v41
    s_nop 1
    v_permlane32_swap_b32 v42, v41
    s_nop 0
    v_add_f32 v41, v41, v42
    v_lshlrev_b32 v42, 3, v7
    s_lshl_b32 s46, s44, 6
    v_add_u32 v43, s46, v42
    s_mov_b64 exec, 0xff
    ds_write_b64 v43, v[40:41] offset:36864
    s_mov_b64 exec, 1
    v_mov_b32 v44, 0
    v_mov_b32 v45, 1
    ds_add_u32 v44, v45 offset:47296
    s_mov_b64 exec, -1
    s_waitcnt vmcnt(8)
    buffer_load_dwordx4 v[200:203], v3, s[20:23], s53 offen nt
    s_add_u32 s53, s53, 9216
    s_waitcnt vmcnt(8)
    buffer_load_dwordx4 v[204:207], v3, s[20:23], s53 offen nt
    s_add_u32 s53, s53, 525312
    s_lshl_b32 s46, s44, 4
    v_lshl_add_u32 v13, v6, 1, s46
    buffer_load_ushort v13, v13, s[36:39], s52 offen
    s_waitcnt vmcnt(9)
    buffer_load_dwordx4 v[208:211], v14, s[20:23], s53 offen nt
    s_waitcnt vmcnt(5)
    buffer_load_dwordx4 v[48:51], v2, s[4:7], s64 offen offset:0 nt
    s_mov_b32 s47, 32000000
    v_mov_b32 v45, 0
L_ln_top_50:
    ds_read_b32 v44, v45 offset:47296
    s_waitcnt lgkmcnt(0)
    v_readfirstlane_b32 s46, v44
    s_sub_u32 s47, s47, 1
    s_cbranch_scc1 L_ln_ok_51
    s_cmp_lt_u32 s46, 8
    s_cbranch_scc1 L_ln_top_50
L_ln_ok_51:
    ds_read_b64 v[232:233], v42 offset:36864
    ds_read_b64 v[234:235], v42 offset:36928
    ds_read_b64 v[236:237], v42 offset:36992
    ds_read_b64 v[238:239], v42 offset:37056
    ds_read_b64 v[240:241], v42 offset:37120
    ds_read_b64 v[242:243], v42 offset:37184
    ds_read_b64 v[244:245], v42 offset:37248
    ds_read_b64 v[246:247], v42 offset:37312
    s_waitcnt lgkmcnt(0)
    v_add_f32 v40, v232, v234
    v_add_f32 v41, v233, v235
    v_add_f32 v40, v40, v236
    v_add_f32 v41, v41, v237
    v_add_f32 v40, v40, v238
    v_add_f32 v41, v41, v239
    v_add_f32 v40, v40, v240
    v_add_f32 v41, v41, v241
    v_add_f32 v40, v40, v242
    v_add_f32 v41, v41, v243
    v_add_f32 v40, v40, v244
    v_add_f32 v41, v41, v245
    v_add_f32 v40, v40, v246
    v_add_f32 v41, v41, v247
    v_mul_f32 v40, 0x3e000000, v40
    v_mul_f32 v41, 0x3c638e39, v41
    v_sub_f32 v43, v232, v40
    v_fmac_f32 v41, v43, v43
    v_sub_f32 v43, v234, v40
    v_fmac_f32 v41, v43, v43
    v_sub_f32 v43, v236, v40
    v_fmac_f32 v41, v43, v43
    v_sub_f32 v43, v238, v40
    v_fmac_f32 v41, v43, v43
    v_sub_f32 v43, v240, v40
    v_fmac_f32 v41, v43, v43
    v_sub_f32 v43, v242, v40
    v_fmac_f32 v41, v43, v43
    v_sub_f32 v43, v244, v40
    v_fmac_f32 v41, v43, v43
    v_sub_f32 v43, v246, v40
    v_fmac_f32 v41, v43, v43
    v_mul_f32 v41, 0x3e000000, v41
    v_add_f32 v41, 0x3727c5ac, v41
    v_rsq_f32 v41, v41
    v_sub_f32 v16, v16, v40
    v_sub_f32 v17, v17, v40
    v_sub_f32 v18, v18, v40
    v_sub_f32 v19, v19, v40
    v_sub_f32 v20, v20, v40
    v_sub_f32 v21, v21, v40
    v_sub_f32 v22, v22, v40
    v_sub_f32 v23, v23, v40
    v_sub_f32 v24, v24, v40
    v_mul_f32 v16, v16, v41
    v_mul_f32 v17, v17, v41
    v_mul_f32 v18, v18, v41
    v_mul_f32 v19, v19, v41
    v_mul_f32 v20, v20, v41
    v_mul_f32 v21, v21, v41
    v_mul_f32 v22, v22, v41
    v_mul_f32 v23, v23, v41
    v_mul_f32 v24, v24, v41
    v_cvt_pk_bf16_f32 v8, v16, v17
    v_cvt_pk_bf16_f32 v9, v18, v19
    v_cvt_pk_bf16_f32 v10, v20, v21
    v_cvt_pk_bf16_f32 v11, v22, v23
    v_cvt_pk_bf16_f32 v12, v24, 0
    buffer_load_dword v250, v249, s[12:15], s79 offen offset:1024 sc1
    s_waitcnt vmcnt(6)
    buffer_load_dwordx4 v[52:55], v2, s[4:7], s64 offen offset:1024 nt
    s_mov_b32 s48, 0x05040100
    s_mov_b32 s49, 0x07060302
    v_mov_b32 v212, 0
    v_mov_b32 v213, 0
    v_mov_b32 v214, v12
    v_mov_b32 v215, 0
    v_mov_b32 v216, 0
    v_mov_b32 v217, 0
    v_mov_b32 v218, 0
    v_mov_b32 v219, v12
    v_mov_b32 v220, 0
    v_mov_b32 v221, 0
    v_lshlrev_b32 v222, 16, v12
    v_mov_b32 v223, 0
    v_mov_b32 v224, 0
    v_mov_b32 v225, 0
    v_mov_b32 v226, 0
    v_lshlrev_b32 v227, 16, v12
    v_mov_b32 v228, 0
    v_mov_b32 v229, 0
    s_waitcnt vmcnt(6)
    s_cmp_eq_u32 s65, 0
    s_cbranch_scc1 L_nt_52
    s_waitcnt vmcnt(5)
L_nt_52:
    buffer_load_dwordx4 v[56:59], v2, s[4:7], s64 offen offset:2048 nt
    s_waitcnt vmcnt(6)
    s_cmp_eq_u32 s65, 0
    s_cbranch_scc1 L_nt_53
    s_waitcnt vmcnt(4)
L_nt_53:
    buffer_load_dwordx4 v[60:63], v2, s[4:7], s64 offen offset:3072 nt
    s_waitcnt vmcnt(5)
    s_cmp_eq_u32 s65, 0
    s_cbranch_scc1 L_nt_54
    s_waitcnt vmcnt(4)
L_nt_54:
    s_add_u32 s46, s64, 0x10000
    buffer_load_dwordx4 v[64:67], v2, s[4:7], s46 offen offset:0 nt
    v_perm_b32 v232, v180, v176, s48
    v_perm_b32 v233, v188, v184, s48
    v_perm_b32 v234, v196, v192, s48
    v_perm_b32 v235, v204, v200, s48
    v_mfma_f32_16x16x32_bf16 v[16:19], v[208:211], v[214:217], 0
    s_nop 0
    v_mfma_f32_16x16x32_bf16 v[16:19], v[232:235], v[8:11], v[16:19]
    v_perm_b32 v236, v180, v176, s49
    v_perm_b32 v237, v188, v184, s49
    v_perm_b32 v238, v196, v192, s49
    v_perm_b32 v239, v204, v200, s49
    v_mfma_f32_16x16x32_bf16 v[20:23], v[208:211], v[222:225], 0
    s_nop 0
    v_mfma_f32_16x16x32_bf16 v[20:23], v[236:239], v[8:11], v[20:23]
    v_perm_b32 v240, v181, v177, s48
    v_perm_b32 v241, v189, v185, s48
    v_perm_b32 v242, v197, v193, s48
    v_perm_b32 v243, v205, v201, s48
    v_mfma_f32_16x16x32_bf16 v[24:27], v[208:211], v[218:221], 0
    s_nop 0
    v_mfma_f32_16x16x32_bf16 v[24:27], v[240:243], v[8:11], v[24:27]
    v_perm_b32 v244, v181, v177, s49
    v_perm_b32 v245, v189, v185, s49
    v_perm_b32 v246, v197, v193, s49
    v_perm_b32 v247, v205, v201, s49
    v_mfma_f32_16x16x32_bf16 v[28:31], v[208:211], v[226:229], 0
    s_nop 0
    v_mfma_f32_16x16x32_bf16 v[28:31], v[244:247], v[8:11], v[28:31]
    v_perm_b32 v232, v182, v178, s48
    v_perm_b32 v233, v190, v186, s48
    v_perm_b32 v234, v198, v194, s48
    v_perm_b32 v235, v206, v202, s48
    v_mfma_f32_16x16x32_bf16 v[32:35], v[208:211], v[212:215], 0
    s_nop 0
    v_mfma_f32_16x16x32_bf16 v[32:35], v[232:235], v[8:11], v[32:35]
    v_perm_b32 v236, v182, v178, s49
    v_perm_b32 v237, v190, v186, s49
    v_perm_b32 v238, v198, v194, s49
    v_perm_b32 v239, v206, v202, s49
    v_mfma_f32_16x16x32_bf16 v[36:39], v[208:211], v[220:223], 0
    s_nop 0
    v_mfma_f32_16x16x32_bf16 v[36:39], v[236:239], v[8:11], v[36:39]
    v_perm_b32 v240, v183, v179, s48
    v_perm_b32 v241, v191, v187, s48
    v_perm_b32 v242, v199, v195, s48
    v_perm_b32 v243, v207, v203, s48
    v_mfma_f32_16x16x32_bf16 v[40:43], v[208:211], v[216:219], 0
    s_nop 0
    v_mfma_f32_16x16x32_bf16 v[40:43], v[240:243], v[8:11], v[40:43]
    v_perm_b32 v244, v183, v179, s49
    v_perm_b32 v245, v191, v187, s49
    v_perm_b32 v246, v199, v195, s49
    v_perm_b32 v247, v207, v203, s49
    v_mfma_f32_16x16x32_bf16 v[44:47], v[208:211], v[224:227], 0
    s_nop 0
    v_mfma_f32_16x16x32_bf16 v[44:47], v[244:247], v[8:11], v[44:47]
    v_lshrrev_b32 v5, 5, v1
    v_mul_u32_u24 v5, 2176, v5
    v_and_b32 v8, 7, v1
    v_mul_u32_u24 v8, 272, v8
    v_add_u32 v5, v5, v8
    v_and_b32 v8, 16, v1
    s_mul_i32 s46, s44, 4352
    v_add3_u32 v5, v5, v8, s46
    s_mov_b32 exec_lo, 0x00ff00ff
    s_mov_b32 exec_hi, 0xff00ff00
    ds_write_b128 v5, v[16:19] offset:0
    ds_write_b128 v5, v[20:23] offset:32
    ds_write_b128 v5, v[24:27] offset:64
    ds_write_b128 v5, v[28:31] offset:96
    ds_write_b128 v5, v[32:35] offset:128
    ds_write_b128 v5, v[36:39] offset:160
    ds_write_b128 v5, v[40:43] offset:192
    ds_write_b128 v5, v[44:47] offset:224
    s_mov_b64 exec, 1
    v_mov_b32 v8, 0
    v_mov_b32 v9, 1
    ds_add_u32 v8, v9 offset:47300
    s_mov_b64 exec, -1
    s_waitcnt vmcnt(5)
    s_cmp_eq_u32 s65, 0
    s_cbranch_scc1 L_nt_55
    s_waitcnt vmcnt(3)
L_nt_55:
    s_add_u32 s46, s64, 0x10000
    buffer_load_dwordx4 v[68:71], v2, s[4:7], s46 offen offset:1024 nt
    s_waitcnt vmcnt(4)
    s_cmp_eq_u32 s65, 0
    s_cbranch_scc1 L_nt_56
    s_waitcnt vmcnt(3)
L_nt_56:
    s_add_u32 s46, s64, 0x10000
    buffer_load_dwordx4 v[72:75], v2, s[4:7], s46 offen offset:2048 nt
    v_cmp_ne_u32 vcc, s78, v250
    s_cmp_eq_u64 vcc, 0
    s_cselect_b32 s3, 1, 0
    v_mul_u32_u24 v5, 272, v7
    v_lshl_add_u32 v5, v6, 5, v5
    s_lshl_b32 s46, s44, 2
    v_add_u32 v5, s46, v5
    v_and_b32 v11, 3, v6
    v_lshlrev_b32 v10, 2, v11
    v_lshl_add_u32 v10, v7, 4, v10
    v_lshrrev_b32 v12, 2, v6
    v_lshl_add_u32 v10, v12, 10, v10
    v_lshlrev_b32 v13, 16, v13
    v_lshlrev_b32 v11, 3, v11
    v_mov_b32 v12, s40
    v_alignbit_b32 v11, v12, v12, v11
    s_mov_b32 s47, 32000000
    v_mov_b32 v9, 0
L_uc_top_57:
    ds_read_b32 v8, v9 offset:47300
    s_waitcnt lgkmcnt(0)
    v_readfirstlane_b32 s46, v8
    s_sub_u32 s47, s47, 1
    s_cbranch_scc1 L_uc_ok_58
    s_cmp_lt_u32 s46, 8
    s_cbranch_scc1 L_uc_top_57
L_uc_ok_58:
    ds_read_b32 v16, v5 offset:0
    ds_read_b32 v17, v5 offset:2176
    ds_read_b32 v18, v5 offset:4352
    ds_read_b32 v19, v5 offset:6528
    ds_read_b32 v20, v5 offset:8704
    ds_read_b32 v21, v5 offset:10880
    ds_read_b32 v22, v5 offset:13056
    ds_read_b32 v23, v5 offset:15232
    ds_read_b32 v24, v5 offset:17408
    ds_read_b32 v25, v5 offset:19584
    ds_read_b32 v26, v5 offset:21760
    ds_read_b32 v27, v5 offset:23936
    ds_read_b32 v28, v5 offset:26112
    ds_read_b32 v29, v5 offset:28288
    ds_read_b32 v30, v5 offset:30464
    ds_read_b32 v31, v5 offset:32640
    v_lshlrev_b32 v9, 2, v1
    s_cmp_eq_u32 s51, 8
    s_cselect_b64 vcc, -1, 0
    v_cndmask_b32 v10, v10, v9, vcc
    s_waitcnt lgkmcnt(0)
    v_add_f32 v16, v16, v24
    v_add_f32 v17, v17, v25
    v_add_f32 v18, v18, v26
    v_add_f32 v19, v19, v27
    v_add_f32 v20, v20, v28
    v_add_f32 v21, v21, v29
    v_add_f32 v22, v22, v30
    v_add_f32 v23, v23, v31
    v_add_f32 v16, v16, v20
    v_add_f32 v17, v17, v21
    v_add_f32 v18, v18, v22
    v_add_f32 v19, v19, v23
    v_add_f32 v16, v16, v18
    v_add_f32 v17, v17, v19
    v_add_f32 v16, v16, v17
    s_mov_b32 s50, s45
    v_mov_b32 v8, v10
    s_cmp_eq_u32 s59, 0
    s_cbranch_scc1 L_unrm_59
    s_mov_b32 s50, s58
    s_cmp_eq_u32 s59, 2
    s_cselect_b32 s50, s50, 0x40000000
    s_movk_i32 s49, 0xff
    v_mov_b32 v8, v9
    v_bfi_b32 v14, s49, v11, v16
    s_branch L_udn_60
L_unrm_59:
    v_add_f32 v16, v16, v13
    v_mul_f32 v17, v16, v16
    v_mov_b32 v18, 0x3d372713
    v_fma_f32 v17, v17, v18, 1.0
    v_mul_f32 v17, v17, v16
    v_mul_f32 v17, 0xc0135761, v17
    v_exp_f32 v17, v17
    s_nop 0
    v_add_f32 v17, 1.0, v17
    v_rcp_f32 v17, v17
    s_nop 0
    v_mul_f32 v16, v16, v17
    v_cvt_pk_bf16_f32 v16, v16, v16
    s_mov_b32 s49, 0xffff
    v_bfi_b32 v14, s49, v11, v16
L_udn_60:
    s_cmp_eq_u32 s3, 1
    s_cbranch_scc1 L_stl_61
    buffer_store_dword v14, v8, s[12:15], s50 offen sc1
    s_branch L_std_62
L_stl_61:
    buffer_store_dword v14, v8, s[12:15], s50 offen
L_std_62:
    s_cmp_eq_u32 s59, 1
    s_cselect_b32 s58, s58, 0x40000000
    s_cmp_eq_u32 s59, 1
    s_cselect_b32 s45, s45, 0x40000000
    s_waitcnt vmcnt(5)
    s_cmp_eq_u32 s65, 0
    s_cbranch_scc1 L_nt_63
    s_waitcnt vmcnt(4)
L_nt_63:
    s_add_u32 s46, s64, 0x10000
    buffer_load_dwordx4 v[76:79], v2, s[4:7], s46 offen offset:3072 nt
    s_waitcnt vmcnt(5)
    s_cmp_eq_u32 s65, 0
    s_cbranch_scc1 L_nt_64
    s_waitcnt vmcnt(4)
L_nt_64:
    s_add_u32 s46, s64, 0x20000
    buffer_load_dwordx4 v[80:83], v2, s[4:7], s46 offen offset:0 nt
    s_waitcnt vmcnt(5)
    s_cmp_eq_u32 s65, 0
    s_cbranch_scc1 L_nt_65
    s_waitcnt vmcnt(4)
L_nt_65:
    s_add_u32 s46, s64, 0x20000
    buffer_load_dwordx4 v[84:87], v2, s[4:7], s46 offen offset:1024 nt
    s_waitcnt vmcnt(5)
    s_cmp_eq_u32 s65, 0
    s_cbranch_scc1 L_nt_66
    s_waitcnt vmcnt(4)
L_nt_66:
    s_add_u32 s46, s64, 0x20000
    buffer_load_dwordx4 v[88:91], v2, s[4:7], s46 offen offset:2048 nt
    s_waitcnt vmcnt(5)
    s_cmp_eq_u32 s65, 0
    s_cbranch_scc1 L_nt_67
    s_waitcnt vmcnt(3)
L_nt_67:
    s_add_u32 s46, s64, 0x20000
    buffer_load_dwordx4 v[92:95], v2, s[4:7], s46 offen offset:3072 nt
    s_waitcnt vmcnt(4)
    s_cmp_eq_u32 s65, 0
    s_cbranch_scc1 L_nt_68
    s_waitcnt vmcnt(3)
L_nt_68:
    s_add_u32 s46, s64, 0x30000
    buffer_load_dwordx4 v[96:99], v2, s[4:7], s46 offen offset:0 nt
    buffer_load_dword v17, v9, s[12:15], s58 offen sc1
    buffer_load_dword v250, v249, s[12:15], s79 offen offset:1024 sc1
    s_waitcnt vmcnt(6)
    s_cmp_eq_u32 s65, 0
    s_cbranch_scc1 L_nt_69
    s_waitcnt vmcnt(5)
L_nt_69:
    s_add_u32 s46, s64, 0x30000
    buffer_load_dwordx4 v[100:103], v2, s[4:7], s46 offen offset:1024 nt
    s_waitcnt vmcnt(6)
    s_cmp_eq_u32 s65, 0
    s_cbranch_scc1 L_nt_70
    s_waitcnt vmcnt(5)
L_nt_70:
    s_add_u32 s46, s64, 0x30000
    buffer_load_dwordx4 v[104:107], v2, s[4:7], s46 offen offset:2048 nt
    s_waitcnt vmcnt(6)
    s_cmp_eq_u32 s65, 0
    s_cbranch_scc1 L_nt_71
    s_waitcnt vmcnt(5)
L_nt_71:
    s_add_u32 s46, s64, 0x30000
    buffer_load_dwordx4 v[108:111], v2, s[4:7], s46 offen offset:3072 nt
    s_waitcnt vmcnt(6)
    s_cmp_eq_u32 s65, 0
    s_cbranch_scc1 L_nt_72
    s_waitcnt vmcnt(5)
L_nt_72:
    s_add_u32 s46, s64, 0x40000
    buffer_load_dwordx4 v[112:115], v2, s[4:7], s46 offen offset:0 nt
    s_waitcnt vmcnt(6)
    s_cmp_eq_u32 s65, 0
    s_cbranch_scc1 L_nt_73
    s_waitcnt vmcnt(3)
L_nt_73:
    s_add_u32 s46, s64, 0x40000
    buffer_load_dwordx4 v[116:119], v2, s[4:7], s46 offen offset:1024 nt
    s_waitcnt vmcnt(4)
    s_cmp_eq_u32 s65, 0
    s_cbranch_scc1 L_nt_74
    s_waitcnt vmcnt(3)
L_nt_74:
    s_add_u32 s46, s64, 0x40000
    buffer_load_dwordx4 v[120:123], v2, s[4:7], s46 offen offset:2048 nt
    v_cmp_ne_u32 vcc, s78, v250
    s_cmp_eq_u64 vcc, 0
    s_cselect_b32 s3, 1, 0
    s_cmp_lg_u32 s59, 1
    s_cbranch_scc1 L_nomain_75
    s_mov_b32 s47, 2000000
L_hf_top_76:
    v_xor_b32 v18, v17, v11
    v_and_b32 v18, 0xff, v18
    v_cmp_ne_u32 vcc, 0, v18
    s_sub_u32 s47, s47, 1
    s_cbranch_scc1 L_hf_ok_77
    s_nop 2
    s_cbranch_vccz L_hf_ok_77
    buffer_load_dword v17, v9, s[12:15], s58 offen sc1
    s_waitcnt vmcnt(0)
    s_branch L_hf_top_76
L_hf_ok_77:
    v_and_b32 v17, 0xffffff00, v17
    v_add_f32 v16, v16, v17
    v_add_f32 v16, v16, v13
    v_mul_f32 v17, v16, v16
    v_mov_b32 v18, 0x3d372713
    v_fma_f32 v17, v17, v18, 1.0
    v_mul_f32 v17, v17, v16
    v_mul_f32 v17, 0xc0135761, v17
    v_exp_f32 v17, v17
    s_nop 0
    v_add_f32 v17, 1.0, v17
    v_rcp_f32 v17, v17
    s_nop 0
    v_mul_f32 v16, v16, v17
    v_cvt_pk_bf16_f32 v16, v16, v16
    s_mov_b32 s49, 0xffff
    v_bfi_b32 v14, s49, v11, v16
L_nomain_75:
    s_cmp_eq_u32 s3, 1
    s_cbranch_scc1 L_stl_78
    buffer_store_dword v14, v10, s[12:15], s45 offen sc1
    s_branch L_std_79
L_stl_78:
    buffer_store_dword v14, v10, s[12:15], s45 offen
L_std_79:
    s_waitcnt vmcnt(5)
    s_cmp_eq_u32 s65, 0
    s_cbranch_scc1 L_nt_80
    s_waitcnt vmcnt(4)
L_nt_80:
    s_add_u32 s46, s64, 0x40000
    buffer_load_dwordx4 v[124:127], v2, s[4:7], s46 offen offset:3072 nt
    s_waitcnt vmcnt(5)
    s_cmp_eq_u32 s65, 0
    s_cbranch_scc1 L_nt_81
    s_waitcnt vmcnt(4)
L_nt_81:
    s_add_u32 s46, s64, 0x50000
    buffer_load_dwordx4 v[128:131], v2, s[4:7], s46 offen offset:0 nt
    s_branch L_common
L_role_Y:
    s_waitcnt lgkmcnt(0)
    s_load_dword s40, s[12:13], 0
    s_mov_b64 s[24:25], s[64:65]
    s_mov_b64 s[16:17], s[72:73]
    v_lshrrev_b32 v5, 6, v0
    v_and_b32 v1, 63, v0
    s_nop 0
    v_readfirstlane_b32 s44, v5
    v_lshlrev_b32 v0, 4, v1
    s_mov_b32 s26, 0x2400
    s_mov_b32 s27, 0x20000
    s_mov_b32 s18, 0x480000
    s_mov_b32 s19, 0x20000
    s_mov_b32 s22, 0x510000
    s_mov_b32 s23, 0x20000
    s_sub_u32 s49, s49, 17
    s_mul_i32 s52, s48, 663552
    s_lshl_b32 s45, s49, 7
    s_add_u32 s52, s52, s45
    v_lshrrev_b32 v6, 3, v1
    v_and_b32 v7, 7, v1
    v_mul_u32_u24 v14, 1152, v6
    v_lshlrev_b32 v3, 3, v14
    v_lshl_add_u32 v3, v7, 4, v3
    v_lshl_add_u32 v14, v7, 4, v14
    s_mul_i32 s53, s44, 82944
    s_add_u32 s53, s53, s52
    buffer_load_dwordx4 v[176:179], v3, s[20:23], s53 offen nt
    s_add_u32 s53, s53, 1152
    buffer_load_dwordx4 v[180:183], v3, s[20:23], s53 offen nt
    s_add_u32 s53, s53, 1152
    buffer_load_dwordx4 v[184:187], v3, s[20:23], s53 offen nt
    s_add_u32 s53, s53, 1152
    buffer_load_dwordx4 v[188:191], v3, s[20:23], s53 offen nt
    s_add_u32 s53, s53, 1152
    buffer_load_dwordx4 v[192:195], v3, s[20:23], s53 offen nt
    s_add_u32 s53, s53, 1152
    s_mov_b64 s[4:5], s[66:67]
    s_mov_b64 s[8:9], s[68:69]
    s_barrier
    s_mov_b32 s10, 0x10000000
    s_mov_b32 s11, 0x20000
    s_mov_b32 s14, 0x168000
    s_mov_b32 s15, 0x20000
    s_and_b32 s60, s2, 7
    s_bfe_u32 s61, s2, 0x10004
    s_lshl1_add_u32 s60, s60, s61
    s_lshr_b32 s61, s2, 5
    s_bfe_u32 s62, s2, 0x10003
    s_lshl4_add_u32 s63, s61, s60
    s_lshl_b32 s64, s63, 21
    s_add_u32 s64, s64, 0x180000
    s_lshl_b32 s63, s63, 1
    s_lshl_b32 s46, s62, 12
    s_add_u32 s64, s64, s46
    s_bfe_u32 s46, s44, 0x10000
    s_lshl_b32 s46, s46, 13
    s_add_u32 s64, s64, s46
    s_bfe_u32 s46, s44, 0x10001
    s_lshl_b32 s46, s46, 14
    s_add_u32 s64, s64, s46
    s_bfe_u32 s46, s44, 0x10002
    s_lshl_b32 s46, s46, 15
    s_add_u32 s64, s64, s46
    v_bfe_u32 v2, v1, 2, 1
    v_lshlrev_b32 v2, 8, v2
    v_bfe_u32 v5, v1, 3, 1
    v_lshl_add_u32 v2, v5, 9, v2
    v_lshrrev_b32 v5, 4, v1
    v_lshl_add_u32 v2, v5, 6, v2
    v_and_b32 v5, 3, v1
    v_lshl_add_u32 v2, v5, 4, v2
    s_mov_b32 s6, 0x10000000
    s_mov_b32 s7, 0x20000
    s_and_b32 s46, s64, 0xfff80000
    s_cmp_eq_u32 s44, 1
    s_cselect_b32 s46, s46, 0x40000000
    s_mul_i32 s47, s60, 294912
    s_cmp_eq_u32 s44, 1
    s_cselect_b32 s47, s47, 0x40000000
    v_mul_u32_u24 v250, 524288, v1
    v_mul_u32_u24 v248, 294912, v1
    s_mov_b64 exec, 0x1
    buffer_load_dword v251, v250, s[4:7], s46 offen nt
    buffer_load_dword v251, v250, s[8:11], s46 offen nt
    buffer_load_dword v251, v248, s[16:19], s47 offen
    s_mov_b64 exec, -1
    s_mov_b32 s101, 1
    s_and_b32 s55, s2, 7
    s_lshr_b32 s56, s2, 3
    s_cmp_ge_u32 s56, 14
    s_cselect_b32 s54, 1, 0
    s_cmp_eq_u32 s44, 7
    s_cselect_b32 s54, s54, 0
    s_sub_u32 s56, s56, 14
    s_mov_b32 s65, 0
    s_mul_i32 s51, s48, 2304
    s_lshl_b32 s49, s49, 8
    s_add_u32 s45, s51, s49
    s_add_u32 s45, s45, 425984
    s_mul_i32 s46, s44, 18432
    s_add_u32 s45, s45, s46
    s_lshl_b32 s51, s48, 3
    s_add_u32 s51, s51, s44
    s_mul_i32 s51, s51, 2304
    s_add_u32 s51, s51, 196608
    s_getreg_b32 s47, hwreg(HW_REG_XCC_ID)
    s_and_b32 s47, s47, 15
    s_lshr_b32 s65, 0x55, s47
    s_and_b32 s65, s65, 1
    s_lshl_b32 s79, s55, 7
    s_lshr_b32 s46, s2, 3
    s_lshl_b32 s46, s46, 2
    s_add_u32 s46, s46, s79
    s_cmp_eq_u32 s44, 0
    s_cselect_b32 s46, s46, 0x40000000
    v_and_b32 v249, 31, v1
    v_lshlrev_b32 v249, 2, v249
    s_waitcnt lgkmcnt(0)
    s_add_u32 s40, s40, 0x01010101
    s_andn2_b32 s78, s40, 15
    s_or_b32 s78, s78, s47
    v_mov_b32 v248, s78
    s_mov_b64 exec, 1
    buffer_store_dword v248, v249, s[12:15], s46 offen offset:1024
    s_mov_b64 exec, -1
    s_lshr_b32 s41, s40, 8
    s_lshl_b32 s46, s40, 24
    s_or_b32 s41, s41, s46
    s_lshr_b32 s42, s40, 16
    s_lshl_b32 s46, s40, 16
    s_or_b32 s42, s42, s46
    s_lshr_b32 s43, s40, 24
    s_lshl_b32 s46, s40, 8
    s_or_b32 s43, s43, s46
    s_and_b32 s28, s40, 0xff
    s_and_b32 s29, s41, 0xff
    s_and_b32 s30, s42, 0xff
    s_and_b32 s31, s43, 0xff
    s_waitcnt vmcnt(8)
    buffer_load_dwordx4 v[196:199], v3, s[20:23], s53 offen nt
    s_add_u32 s53, s53, 1152
    s_waitcnt vmcnt(8)
    buffer_load_dwordx4 v[200:203], v3, s[20:23], s53 offen nt
    s_add_u32 s53, s53, 1152
    s_waitcnt vmcnt(8)
    buffer_load_dwordx4 v[204:207], v3, s[20:23], s53 offen nt
    s_add_u32 s53, s53, 65664
    s_waitcnt vmcnt(8)
    buffer_load_dwordx4 v[208:211], v14, s[20:23], s53 offen nt
    s_waitcnt vmcnt(8)
    buffer_load_dwordx4 v[48:51], v2, s[4:7], s64 offen offset:0 nt
    s_waitcnt vmcnt(4)
    buffer_load_dwordx4 v[52:55], v2, s[4:7], s64 offen offset:1024 nt
    s_waitcnt vmcnt(4)
    s_cmp_eq_u32 s65, 0
    s_cbranch_scc1 L_nt_82
    s_waitcnt vmcnt(3)
L_nt_82:
    buffer_load_dwordx4 v[56:59], v2, s[4:7], s64 offen offset:2048 nt
    s_waitcnt vmcnt(4)
    s_cmp_eq_u32 s65, 0
    s_cbranch_scc1 L_nt_83
    s_waitcnt vmcnt(3)
L_nt_83:
    buffer_load_dwordx4 v[60:63], v2, s[4:7], s64 offen offset:3072 nt
    s_waitcnt vmcnt(4)
    s_cmp_eq_u32 s65, 0
    s_cbranch_scc1 L_nt_84
    s_waitcnt vmcnt(3)
L_nt_84:
    s_add_u32 s46, s64, 0x10000
    buffer_load_dwordx4 v[64:67], v2, s[4:7], s46 offen offset:0 nt
    s_waitcnt vmcnt(4)
    s_cmp_eq_u32 s65, 0
    s_cbranch_scc1 L_nt_85
    s_waitcnt vmcnt(3)
L_nt_85:
    s_add_u32 s46, s64, 0x10000
    buffer_load_dwordx4 v[68:71], v2, s[4:7], s46 offen offset:1024 nt
    s_waitcnt vmcnt(4)
    s_cmp_eq_u32 s65, 0
    s_cbranch_scc1 L_nt_86
    s_waitcnt vmcnt(3)
L_nt_86:
    s_add_u32 s46, s64, 0x10000
    buffer_load_dwordx4 v[72:75], v2, s[4:7], s46 offen offset:2048 nt
    s_waitcnt vmcnt(4)
    s_cmp_eq_u32 s65, 0
    s_cbranch_scc1 L_nt_87
    s_waitcnt vmcnt(3)
L_nt_87:
    s_add_u32 s46, s64, 0x10000
    buffer_load_dwordx4 v[76:79], v2, s[4:7], s46 offen offset:3072 nt
    s_waitcnt vmcnt(4)
    s_cmp_eq_u32 s65, 0
    s_cbranch_scc1 L_nt_88
    s_waitcnt vmcnt(3)
L_nt_88:
    s_add_u32 s46, s64, 0x20000
    buffer_load_dwordx4 v[80:83], v2, s[4:7], s46 offen offset:0 nt
    s_waitcnt vmcnt(4)
    s_cmp_eq_u32 s65, 0
    s_cbranch_scc1 L_nt_89
    s_waitcnt vmcnt(3)
L_nt_89:
    s_add_u32 s46, s64, 0x20000
    buffer_load_dwordx4 v[84:87], v2, s[4:7], s46 offen offset:1024 nt
    s_waitcnt vmcnt(4)
    s_cmp_eq_u32 s65, 0
    s_cbranch_scc1 L_nt_90
    s_waitcnt vmcnt(3)
L_nt_90:
    s_add_u32 s46, s64, 0x20000
    buffer_load_dwordx4 v[88:91], v2, s[4:7], s46 offen offset:2048 nt
    s_waitcnt vmcnt(4)
    s_cmp_eq_u32 s65, 0
    s_cbranch_scc1 L_nt_91
    s_waitcnt vmcnt(3)
L_nt_91:
    s_add_u32 s46, s64, 0x20000
    buffer_load_dwordx4 v[92:95], v2, s[4:7], s46 offen offset:3072 nt
    s_waitcnt vmcnt(4)
    s_cmp_eq_u32 s65, 0
    s_cbranch_scc1 L_nt_92
    s_waitcnt vmcnt(3)
L_nt_92:
    s_add_u32 s46, s64, 0x30000
    buffer_load_dwordx4 v[96:99], v2, s[4:7], s46 offen offset:0 nt
    buffer_load_dword v250, v249, s[12:15], s79 offen offset:1024 sc1
    s_waitcnt vmcnt(5)
    s_cmp_eq_u32 s65, 0
    s_cbranch_scc1 L_nt_93
    s_waitcnt vmcnt(4)
L_nt_93:
    s_add_u32 s46, s64, 0x30000
    buffer_load_dwordx4 v[100:103], v2, s[4:7], s46 offen offset:1024 nt
    s_waitcnt vmcnt(5)
    s_cmp_eq_u32 s65, 0
    s_cbranch_scc1 L_nt_94
    s_waitcnt vmcnt(4)
L_nt_94:
    s_add_u32 s46, s64, 0x30000
    buffer_load_dwordx4 v[104:107], v2, s[4:7], s46 offen offset:2048 nt
    s_waitcnt vmcnt(5)
    s_cmp_eq_u32 s65, 0
    s_cbranch_scc1 L_nt_95
    s_waitcnt vmcnt(4)
L_nt_95:
    s_add_u32 s46, s64, 0x30000
    buffer_load_dwordx4 v[108:111], v2, s[4:7], s46 offen offset:3072 nt
    s_waitcnt vmcnt(5)
    s_cmp_eq_u32 s65, 0
    s_cbranch_scc1 L_nt_96
    s_waitcnt vmcnt(4)
L_nt_96:
    s_add_u32 s46, s64, 0x40000
    buffer_load_dwordx4 v[112:115], v2, s[4:7], s46 offen offset:0 nt
    s_waitcnt vmcnt(5)
    s_cmp_eq_u32 s65, 0
    s_cbranch_scc1 L_nt_97
    s_waitcnt vmcnt(3)
L_nt_97:
    s_add_u32 s46, s64, 0x40000
    buffer_load_dwordx4 v[116:119], v2, s[4:7], s46 offen offset:1024 nt
    s_waitcnt vmcnt(4)
    s_cmp_eq_u32 s65, 0
    s_cbranch_scc1 L_nt_98
    s_waitcnt vmcnt(3)
L_nt_98:
    s_add_u32 s46, s64, 0x40000
    buffer_load_dwordx4 v[120:123], v2, s[4:7], s46 offen offset:2048 nt
    v_cmp_ne_u32 vcc, s78, v250
    s_cmp_eq_u64 vcc, 0
    s_cselect_b32 s3, 1, 0
    s_waitcnt vmcnt(4)
    s_cmp_eq_u32 s65, 0
    s_cbranch_scc1 L_nt_99
    s_waitcnt vmcnt(3)
L_nt_99:
    s_add_u32 s46, s64, 0x40000
    buffer_load_dwordx4 v[124:127], v2, s[4:7], s46 offen offset:3072 nt
    s_waitcnt vmcnt(4)
    s_cmp_eq_u32 s65, 0
    s_cbranch_scc1 L_nt_100
    s_waitcnt vmcnt(3)
L_nt_100:
    s_add_u32 s46, s64, 0x50000
    buffer_load_dwordx4 v[128:131], v2, s[4:7], s46 offen offset:0 nt
    s_branch L_common
L_common:
    s_waitcnt vmcnt(4)
    s_cmp_eq_u32 s65, 0
    s_cbranch_scc1 L_nt_101
    s_waitcnt vmcnt(3)
L_nt_101:
    s_add_u32 s46, s64, 0x50000
    buffer_load_dwordx4 v[132:135], v2, s[4:7], s46 offen offset:1024 nt
    s_mul_i32 s76, s63, 3328
    s_add_u32 s76, s76, 622592
    s_mul_i32 s74, s62, 3328
    s_sub_u32 s77, 3328, s74
    s_add_u32 s74, s74, s76
    s_add_u32 s77, s77, s76
    v_lshrrev_b32 v5, 4, v1
    v_mul_u32_u24 v4, 4608, v5
    v_and_b32 v5, 15, v1
    v_lshl_add_u32 v4, v5, 4, v4
    s_lshl_b32 s72, s60, 1
    s_lshr_b32 s46, s44, 2
    s_add_u32 s72, s72, s46
    s_lshl_b32 s72, s72, 1
    s_add_u32 s72, s72, s62
    s_lshl_b32 s72, s72, 2
    s_and_b32 s46, s44, 3
    s_add_u32 s72, s72, s46
    s_mul_i32 s72, s72, 18432
    s_add_u32 s73, s72, 2304
    v_and_b32 v5, 1, v1
    v_lshlrev_b32 v5, 4, v5
    v_mov_b32 v6, 0xffff
    v_lshlrev_b32 v5, v5, v6
    v_bfe_u32 v6, v1, 1, 2
    v_cmp_eq_u32 vcc, 0, v6
    s_nop 1
    v_cndmask_b32 v8, 0, v5, vcc
    v_cmp_eq_u32 vcc, 1, v6
    s_nop 1
    v_cndmask_b32 v9, 0, v5, vcc
    v_cmp_eq_u32 vcc, 2, v6
    s_nop 1
    v_cndmask_b32 v10, 0, v5, vcc
    v_cmp_eq_u32 vcc, 3, v6
    s_nop 1
    v_cndmask_b32 v11, 0, v5, vcc
    v_bfe_i32 v42, v1, 2, 1
    v_mov_b32 v7, 0xff
    v_bfe_u32 v3, v1, 3, 1
    v_lshlrev_b32 v3, 10, v3
    v_bfe_u32 v5, v1, 4, 1
    v_lshl_add_u32 v3, v5, 8, v3
    v_lshrrev_b32 v5, 5, v1
    v_lshl_add_u32 v3, v5, 9, v3
    v_and_b32 v5, 7, v1
    v_lshl_add_u32 v3, v5, 4, v3
    s_xor_b32 s46, s62, 1
    s_lshl_b32 s46, s46, 7
    v_add_u32 v3, s46, v3
    s_waitcnt vmcnt(4)
    s_cmp_eq_u32 s65, 0
    s_cbranch_scc1 L_nt_102
    s_waitcnt vmcnt(3)
L_nt_102:
    s_add_u32 s46, s64, 0x50000
    buffer_load_dwordx4 v[136:139], v2, s[4:7], s46 offen offset:2048 nt
    s_waitcnt vmcnt(4)
    s_cmp_eq_u32 s65, 0
    s_cbranch_scc1 L_nt_103
    s_waitcnt vmcnt(3)
L_nt_103:
    s_add_u32 s46, s64, 0x50000
    buffer_load_dwordx4 v[140:143], v2, s[4:7], s46 offen offset:3072 nt
    s_waitcnt vmcnt(4)
    s_cmp_eq_u32 s65, 0
    s_cbranch_scc1 L_nt_104
    s_waitcnt vmcnt(3)
L_nt_104:
    s_add_u32 s46, s64, 0x60000
    buffer_load_dwordx4 v[144:147], v2, s[4:7], s46 offen offset:0 nt
    s_waitcnt vmcnt(4)
    s_cmp_eq_u32 s65, 0
    s_cbranch_scc1 L_nt_105
    s_waitcnt vmcnt(3)
L_nt_105:
    s_add_u32 s46, s64, 0x60000
    buffer_load_dwordx4 v[148:151], v2, s[4:7], s46 offen offset:1024 nt
    s_waitcnt vmcnt(4)
    s_cmp_eq_u32 s65, 0
    s_cbranch_scc1 L_nt_106
    s_waitcnt vmcnt(3)
L_nt_106:
    s_add_u32 s46, s64, 0x60000
    buffer_load_dwordx4 v[152:155], v2, s[4:7], s46 offen offset:2048 nt
    s_mul_i32 s75, s61, 16640
    s_lshl_b32 s46, s60, 10
    s_add_u32 s75, s75, s46
    s_add_u32 s75, s75, 4096
    s_cmp_eq_u32 s44, 1
    s_cselect_b32 s75, s75, 0x40000000
    buffer_load_dwordx4 v[44:47], v0, s[12:15], s75 offen sc1
    s_waitcnt vmcnt(5)
    s_cmp_eq_u32 s65, 0
    s_cbranch_scc1 L_nt_107
    s_waitcnt vmcnt(4)
L_nt_107:
    s_add_u32 s46, s64, 0x60000
    buffer_load_dwordx4 v[156:159], v2, s[4:7], s46 offen offset:3072 nt
    s_waitcnt vmcnt(5)
    s_cmp_eq_u32 s65, 0
    s_cbranch_scc1 L_nt_108
    s_waitcnt vmcnt(4)
L_nt_108:
    s_add_u32 s46, s64, 0x70000
    buffer_load_dwordx4 v[160:163], v2, s[4:7], s46 offen offset:0 nt
    s_waitcnt vmcnt(5)
    s_cmp_eq_u32 s65, 0
    s_cbranch_scc1 L_nt_109
    s_waitcnt vmcnt(4)
L_nt_109:
    s_add_u32 s46, s64, 0x70000
    buffer_load_dwordx4 v[164:167], v2, s[4:7], s46 offen offset:1024 nt
    s_waitcnt vmcnt(5)
    s_cmp_eq_u32 s65, 0
    s_cbranch_scc1 L_nt_110
    s_waitcnt vmcnt(4)
L_nt_110:
    s_add_u32 s46, s64, 0x70000
    buffer_load_dwordx4 v[168:171], v2, s[4:7], s46 offen offset:2048 nt
    s_waitcnt vmcnt(5)
    s_cmp_eq_u32 s65, 0
    s_cbranch_scc1 L_nt_111
    s_waitcnt vmcnt(3)
L_nt_111:
    s_add_u32 s46, s64, 0x70000
    buffer_load_dwordx4 v[172:175], v2, s[4:7], s46 offen offset:3072 nt
    s_waitcnt vmcnt(4)
    s_cmp_eq_u32 s65, 0
    s_cbranch_scc1 L_nt_112
    s_waitcnt vmcnt(3)
L_nt_112:
    buffer_load_dwordx4 v[212:215], v3, s[8:11], s64 offen offset:0 nt
    s_cmp_lg_u32 s44, 1
    s_cbranch_scc1 L_only_113
    s_mov_b32 s47, 2000000
L_qp_top_114:
    v_xor_b32 v43, s40, v44
    v_bitop3_b32 v43, v45, s41, v43 bitop3:0xbe
    v_bitop3_b32 v43, v46, s42, v43 bitop3:0xbe
    v_bitop3_b32 v43, v47, s43, v43 bitop3:0xbe
    v_and_b32 v43, 0xffff, v43
    v_cmp_ne_u32 vcc, 0, v43
    s_sub_u32 s47, s47, 1
    s_cbranch_scc1 L_qp_ok_115
    s_nop 2
    s_cbranch_vccz L_qp_ok_115
    buffer_load_dwordx4 v[44:47], v0, s[12:15], s75 offen sc1
    s_waitcnt vmcnt(0)
    s_branch L_qp_top_114
L_qp_ok_115:
    s_mov_b32 s46, 0x07060302
    v_perm_b32 v44, v45, v44, s46
    v_perm_b32 v45, v47, v46, s46
    v_lshlrev_b32 v43, 3, v1
    ds_write_b64 v43, v[44:45] offset:46592
    s_mov_b64 exec, 1
    v_mov_b32 v46, 0
    v_mov_b32 v47, 1
    ds_add_u32 v46, v47 offset:47304
    s_mov_b64 exec, -1
L_only_113:
    s_waitcnt vmcnt(4)
    s_cmp_eq_u32 s65, 0
    s_cbranch_scc1 L_nt_116
    s_waitcnt vmcnt(3)
L_nt_116:
    buffer_load_dwordx4 v[216:219], v3, s[8:11], s64 offen offset:2048 nt
    s_waitcnt vmcnt(4)
    s_cmp_eq_u32 s65, 0
    s_cbranch_scc1 L_nt_117
    s_waitcnt vmcnt(3)
L_nt_117:
    s_add_u32 s46, s64, 0x10000
    buffer_load_dwordx4 v[220:223], v3, s[8:11], s46 offen offset:0 nt
    v_bfe_u32 v43, v1, 3, 1
    v_lshlrev_b32 v43, 8, v43
    v_lshrrev_b32 v5, 4, v1
    v_lshl_add_u32 v43, v5, 6, v43
    v_and_b32 v5, 3, v1
    v_lshl_add_u32 v43, v5, 4, v43
    s_mov_b32 s47, 32000000
    v_mov_b32 v41, 0
L_qc_top_118:
    ds_read_b32 v40, v41 offset:47304
    s_waitcnt lgkmcnt(0)
    v_readfirstlane_b32 s46, v40
    s_sub_u32 s47, s47, 1
    s_cbranch_scc1 L_qc_ok_119
    s_cmp_lt_u32 s46, 1
    s_cbranch_scc1 L_qc_top_118
L_qc_ok_119:
    ds_read_b128 v[44:47], v43 offset:46592
    s_waitcnt lgkmcnt(0)
    v_bfi_b32 v32, v42, 0, v44
    v_and_b32 v36, v42, v44
    v_bfi_b32 v33, v42, 0, v45
    v_and_b32 v37, v42, v45
    v_bfi_b32 v34, v42, 0, v46
    v_and_b32 v38, v42, v46
    v_bfi_b32 v35, v42, 0, v47
    v_and_b32 v39, v42, v47
    s_nop 1
    v_mfma_f32_16x16x32_bf16 v[232:235], v[48:51], v[32:35], 0
    v_mfma_f32_16x16x32_bf16 v[232:235], v[52:55], v[36:39], v[232:235]
    s_nop 3
    v_mfma_f32_16x16x32_bf16 v[236:239], v[56:59], v[32:35], 0
    v_mfma_f32_16x16x32_bf16 v[236:239], v[60:63], v[36:39], v[236:239]
    s_nop 3
    v_mfma_f32_16x16x32_bf16 v[240:243], v[64:67], v[32:35], 0
    v_mfma_f32_16x16x32_bf16 v[240:243], v[68:71], v[36:39], v[240:243]
    v_mov_b32_dpp v16, v232 quad_perm:[0,0,0,0] row_mask:0xf bank_mask:0xf
    v_add_f32_dpp v16, v233, v16 quad_perm:[1,1,1,1] row_mask:0xf bank_mask:0xf
    v_add_f32_dpp v16, v234, v16 quad_perm:[2,2,2,2] row_mask:0xf bank_mask:0xf
    v_add_f32_dpp v16, v235, v16 quad_perm:[3,3,3,3] row_mask:0xf bank_mask:0xf
    s_waitcnt vmcnt(4)
    s_cmp_eq_u32 s65, 0
    s_cbranch_scc1 L_nt_120
    s_waitcnt vmcnt(3)
L_nt_120:
    s_add_u32 s46, s64, 0x10000
    buffer_load_dwordx4 v[224:227], v3, s[8:11], s46 offen offset:2048 nt
    v_mfma_f32_16x16x32_bf16 v[244:247], v[72:75], v[32:35], 0
    v_mfma_f32_16x16x32_bf16 v[244:247], v[76:79], v[36:39], v[244:247]
    v_mov_b32_dpp v17, v236 quad_perm:[0,0,0,0] row_mask:0xf bank_mask:0xf
    v_add_f32_dpp v17, v237, v17 quad_perm:[1,1,1,1] row_mask:0xf bank_mask:0xf
    v_add_f32_dpp v17, v238, v17 quad_perm:[2,2,2,2] row_mask:0xf bank_mask:0xf
    v_add_f32_dpp v17, v239, v17 quad_perm:[3,3,3,3] row_mask:0xf bank_mask:0xf
    v_mfma_f32_16x16x32_bf16 v[232:235], v[80:83], v[32:35], 0
    v_mfma_f32_16x16x32_bf16 v[232:235], v[84:87], v[36:39], v[232:235]
    v_mov_b32_dpp v18, v240 quad_perm:[0,0,0,0] row_mask:0xf bank_mask:0xf
    v_add_f32_dpp v18, v241, v18 quad_perm:[1,1,1,1] row_mask:0xf bank_mask:0xf
    v_add_f32_dpp v18, v242, v18 quad_perm:[2,2,2,2] row_mask:0xf bank_mask:0xf
    v_add_f32_dpp v18, v243, v18 quad_perm:[3,3,3,3] row_mask:0xf bank_mask:0xf
    v_mfma_f32_16x16x32_bf16 v[236:239], v[88:91], v[32:35], 0
    v_mfma_f32_16x16x32_bf16 v[236:239], v[92:95], v[36:39], v[236:239]
    v_mov_b32_dpp v19, v244 quad_perm:[0,0,0,0] row_mask:0xf bank_mask:0xf
    v_add_f32_dpp v19, v245, v19 quad_perm:[1,1,1,1] row_mask:0xf bank_mask:0xf
    v_add_f32_dpp v19, v246, v19 quad_perm:[2,2,2,2] row_mask:0xf bank_mask:0xf
    v_add_f32_dpp v19, v247, v19 quad_perm:[3,3,3,3] row_mask:0xf bank_mask:0xf
    v_mfma_f32_16x16x32_bf16 v[240:243], v[96:99], v[32:35], 0
    v_mfma_f32_16x16x32_bf16 v[240:243], v[100:103], v[36:39], v[240:243]
    v_mov_b32_dpp v20, v232 quad_perm:[0,0,0,0] row_mask:0xf bank_mask:0xf
    v_add_f32_dpp v20, v233, v20 quad_perm:[1,1,1,1] row_mask:0xf bank_mask:0xf
    v_add_f32_dpp v20, v234, v20 quad_perm:[2,2,2,2] row_mask:0xf bank_mask:0xf
    v_add_f32_dpp v20, v235, v20 quad_perm:[3,3,3,3] row_mask:0xf bank_mask:0xf
    v_mfma_f32_16x16x32_bf16 v[244:247], v[104:107], v[32:35], 0
    v_mfma_f32_16x16x32_bf16 v[244:247], v[108:111], v[36:39], v[244:247]
    v_mov_b32_dpp v21, v236 quad_perm:[0,0,0,0] row_mask:0xf bank_mask:0xf
    v_add_f32_dpp v21, v237, v21 quad_perm:[1,1,1,1] row_mask:0xf bank_mask:0xf
    v_add_f32_dpp v21, v238, v21 quad_perm:[2,2,2,2] row_mask:0xf bank_mask:0xf
    v_add_f32_dpp v21, v239, v21 quad_perm:[3,3,3,3] row_mask:0xf bank_mask:0xf
    v_mfma_f32_16x16x32_bf16 v[232:235], v[112:115], v[32:35], 0
    v_mfma_f32_16x16x32_bf16 v[232:235], v[116:119], v[36:39], v[232:235]
    v_mov_b32_dpp v22, v240 quad_perm:[0,0,0,0] row_mask:0xf bank_mask:0xf
    v_add_f32_dpp v22, v241, v22 quad_perm:[1,1,1,1] row_mask:0xf bank_mask:0xf
    v_add_f32_dpp v22, v242, v22 quad_perm:[2,2,2,2] row_mask:0xf bank_mask:0xf
    v_add_f32_dpp v22, v243, v22 quad_perm:[3,3,3,3] row_mask:0xf bank_mask:0xf
    v_mfma_f32_16x16x32_bf16 v[236:239], v[120:123], v[32:35], 0
    v_mfma_f32_16x16x32_bf16 v[236:239], v[124:127], v[36:39], v[236:239]
    v_mov_b32_dpp v23, v244 quad_perm:[0,0,0,0] row_mask:0xf bank_mask:0xf
    v_add_f32_dpp v23, v245, v23 quad_perm:[1,1,1,1] row_mask:0xf bank_mask:0xf
    v_add_f32_dpp v23, v246, v23 quad_perm:[2,2,2,2] row_mask:0xf bank_mask:0xf
    v_add_f32_dpp v23, v247, v23 quad_perm:[3,3,3,3] row_mask:0xf bank_mask:0xf
    s_waitcnt vmcnt(4)
    s_cmp_eq_u32 s65, 0
    s_cbranch_scc1 L_nt_121
    s_waitcnt vmcnt(3)
L_nt_121:
    s_add_u32 s46, s64, 0x20000
    buffer_load_dwordx4 v[228:231], v3, s[8:11], s46 offen offset:0 nt
    v_mfma_f32_16x16x32_bf16 v[240:243], v[128:131], v[32:35], 0
    v_mfma_f32_16x16x32_bf16 v[240:243], v[132:135], v[36:39], v[240:243]
    v_mov_b32_dpp v24, v232 quad_perm:[0,0,0,0] row_mask:0xf bank_mask:0xf
    v_add_f32_dpp v24, v233, v24 quad_perm:[1,1,1,1] row_mask:0xf bank_mask:0xf
    v_add_f32_dpp v24, v234, v24 quad_perm:[2,2,2,2] row_mask:0xf bank_mask:0xf
    v_add_f32_dpp v24, v235, v24 quad_perm:[3,3,3,3] row_mask:0xf bank_mask:0xf
    v_mfma_f32_16x16x32_bf16 v[244:247], v[136:139], v[32:35], 0
    v_mfma_f32_16x16x32_bf16 v[244:247], v[140:143], v[36:39], v[244:247]
    v_mov_b32_dpp v25, v236 quad_perm:[0,0,0,0] row_mask:0xf bank_mask:0xf
    v_add_f32_dpp v25, v237, v25 quad_perm:[1,1,1,1] row_mask:0xf bank_mask:0xf
    v_add_f32_dpp v25, v238, v25 quad_perm:[2,2,2,2] row_mask:0xf bank_mask:0xf
    v_add_f32_dpp v25, v239, v25 quad_perm:[3,3,3,3] row_mask:0xf bank_mask:0xf
    v_mfma_f32_16x16x32_bf16 v[232:235], v[144:147], v[32:35], 0
    v_mfma_f32_16x16x32_bf16 v[232:235], v[148:151], v[36:39], v[232:235]
    v_mov_b32_dpp v26, v240 quad_perm:[0,0,0,0] row_mask:0xf bank_mask:0xf
    v_add_f32_dpp v26, v241, v26 quad_perm:[1,1,1,1] row_mask:0xf bank_mask:0xf
    v_add_f32_dpp v26, v242, v26 quad_perm:[2,2,2,2] row_mask:0xf bank_mask:0xf
    v_add_f32_dpp v26, v243, v26 quad_perm:[3,3,3,3] row_mask:0xf bank_mask:0xf
    v_mfma_f32_16x16x32_bf16 v[236:239], v[152:155], v[32:35], 0
    v_mfma_f32_16x16x32_bf16 v[236:239], v[156:159], v[36:39], v[236:239]
    v_mov_b32_dpp v27, v244 quad_perm:[0,0,0,0] row_mask:0xf bank_mask:0xf
    v_add_f32_dpp v27, v245, v27 quad_perm:[1,1,1,1] row_mask:0xf bank_mask:0xf
    v_add_f32_dpp v27, v246, v27 quad_perm:[2,2,2,2] row_mask:0xf bank_mask:0xf
    v_add_f32_dpp v27, v247, v27 quad_perm:[3,3,3,3] row_mask:0xf bank_mask:0xf
    v_mfma_f32_16x16x32_bf16 v[240:243], v[160:163], v[32:35], 0
    v_mfma_f32_16x16x32_bf16 v[240:243], v[164:167], v[36:39], v[240:243]
    v_mov_b32_dpp v28, v232 quad_perm:[0,0,0,0] row_mask:0xf bank_mask:0xf
    v_add_f32_dpp v28, v233, v28 quad_perm:[1,1,1,1] row_mask:0xf bank_mask:0xf
    v_add_f32_dpp v28, v234, v28 quad_perm:[2,2,2,2] row_mask:0xf bank_mask:0xf
    v_add_f32_dpp v28, v235, v28 quad_perm:[3,3,3,3] row_mask:0xf bank_mask:0xf
    v_mfma_f32_16x16x32_bf16 v[244:247], v[168:171], v[32:35], 0
    v_mfma_f32_16x16x32_bf16 v[244:247], v[172:175], v[36:39], v[244:247]
    v_mov_b32_dpp v29, v236 quad_perm:[0,0,0,0] row_mask:0xf bank_mask:0xf
    v_add_f32_dpp v29, v237, v29 quad_perm:[1,1,1,1] row_mask:0xf bank_mask:0xf
    v_add_f32_dpp v29, v238, v29 quad_perm:[2,2,2,2] row_mask:0xf bank_mask:0xf
    v_add_f32_dpp v29, v239, v29 quad_perm:[3,3,3,3] row_mask:0xf bank_mask:0xf
    s_nop 3
    v_mov_b32_dpp v30, v240 quad_perm:[0,0,0,0] row_mask:0xf bank_mask:0xf
    v_add_f32_dpp v30, v241, v30 quad_perm:[1,1,1,1] row_mask:0xf bank_mask:0xf
    v_add_f32_dpp v30, v242, v30 quad_perm:[2,2,2,2] row_mask:0xf bank_mask:0xf
    v_add_f32_dpp v30, v243, v30 quad_perm:[3,3,3,3] row_mask:0xf bank_mask:0xf
    s_nop 1
    v_mov_b32_dpp v31, v244 quad_perm:[0,0,0,0] row_mask:0xf bank_mask:0xf
    v_add_f32_dpp v31, v245, v31 quad_perm:[1,1,1,1] row_mask:0xf bank_mask:0xf
    v_add_f32_dpp v31, v246, v31 quad_perm:[2,2,2,2] row_mask:0xf bank_mask:0xf
    v_add_f32_dpp v31, v247, v31 quad_perm:[3,3,3,3] row_mask:0xf bank_mask:0xf
    v_max3_f32 v44, v16, v17, v18
    v_max3_f32 v44, v44, v19, v20
    v_max3_f32 v44, v44, v21, v22
    v_max3_f32 v44, v44, v23, v24
    v_max3_f32 v44, v44, v25, v26
    v_max3_f32 v44, v44, v27, v28
    v_max3_f32 v44, v44, v29, v30
    v_max_f32 v44, v44, v31
    s_nop 1
    v_max_f32_dpp v44, v44, v44 row_half_mirror row_mask:0xf bank_mask:0xf
    v_mov_b32 v41, v44
    s_nop 1
    v_permlane16_swap_b32 v41, v44
    s_nop 0
    v_max_f32 v44, v44, v41
    v_mov_b32 v41, v44
    s_nop 1
    v_permlane32_swap_b32 v41, v44
    s_nop 0
    v_max_f32 v44, v44, v41
    s_waitcnt vmcnt(4)
    s_cmp_eq_u32 s65, 0
    s_cbranch_scc1 L_nt_122
    s_waitcnt vmcnt(3)
L_nt_122:
    s_add_u32 s46, s64, 0x20000
    buffer_load_dwordx4 v[48:51], v3, s[8:11], s46 offen offset:2048 nt
    s_mov_b32 s46, 0x3e0293ee
    v_sub_f32 v16, v16, v44
    v_sub_f32 v17, v17, v44
    v_sub_f32 v18, v18, v44
    v_sub_f32 v19, v19, v44
    v_sub_f32 v20, v20, v44
    v_sub_f32 v21, v21, v44
    v_sub_f32 v22, v22, v44
    v_sub_f32 v23, v23, v44
    v_sub_f32 v24, v24, v44
    v_sub_f32 v25, v25, v44
    v_sub_f32 v26, v26, v44
    v_sub_f32 v27, v27, v44
    v_sub_f32 v28, v28, v44
    v_sub_f32 v29, v29, v44
    v_sub_f32 v30, v30, v44
    v_sub_f32 v31, v31, v44
    v_mul_f32 v16, s46, v16
    v_mul_f32 v17, s46, v17
    v_mul_f32 v18, s46, v18
    v_mul_f32 v19, s46, v19
    v_mul_f32 v20, s46, v20
    v_mul_f32 v21, s46, v21
    v_mul_f32 v22, s46, v22
    v_mul_f32 v23, s46, v23
    v_mul_f32 v24, s46, v24
    v_mul_f32 v25, s46, v25
    v_mul_f32 v26, s46, v26
    v_mul_f32 v27, s46, v27
    v_mul_f32 v28, s46, v28
    v_mul_f32 v29, s46, v29
    v_mul_f32 v30, s46, v30
    v_mul_f32 v31, s46, v31
    v_mul_f32 v44, s46, v44
    v_exp_f32 v16, v16
    v_exp_f32 v17, v17
    v_exp_f32 v18, v18
    v_exp_f32 v19, v19
    v_exp_f32 v20, v20
    v_exp_f32 v21, v21
    v_exp_f32 v22, v22
    v_exp_f32 v23, v23
    v_exp_f32 v24, v24
    v_exp_f32 v25, v25
    v_exp_f32 v26, v26
    v_exp_f32 v27, v27
    v_exp_f32 v28, v28
    v_exp_f32 v29, v29
    v_exp_f32 v30, v30
    v_exp_f32 v31, v31
    v_add_f32 v45, v16, v17
    v_add_f32 v45, v45, v18
    v_add_f32 v45, v45, v19
    v_add_f32 v45, v45, v20
    v_add_f32 v45, v45, v21
    v_add_f32 v45, v45, v22
    v_add_f32 v45, v45, v23
    v_add_f32 v45, v45, v24
    v_add_f32 v45, v45, v25
    v_add_f32 v45, v45, v26
    v_add_f32 v45, v45, v27
    v_add_f32 v45, v45, v28
    v_add_f32 v45, v45, v29
    v_add_f32 v45, v45, v30
    v_add_f32 v45, v45, v31
    v_cvt_pk_bf16_f32 v16, v16, v16
    v_cvt_pk_bf16_f32 v17, v17, v17
    v_cvt_pk_bf16_f32 v18, v18, v18
    v_cvt_pk_bf16_f32 v19, v19, v19
    v_cvt_pk_bf16_f32 v20, v20, v20
    v_cvt_pk_bf16_f32 v21, v21, v21
    v_cvt_pk_bf16_f32 v22, v22, v22
    v_cvt_pk_bf16_f32 v23, v23, v23
    v_cvt_pk_bf16_f32 v24, v24, v24
    v_cvt_pk_bf16_f32 v25, v25, v25
    v_cvt_pk_bf16_f32 v26, v26, v26
    v_cvt_pk_bf16_f32 v27, v27, v27
    v_cvt_pk_bf16_f32 v28, v28, v28
    v_cvt_pk_bf16_f32 v29, v29, v29
    v_cvt_pk_bf16_f32 v30, v30, v30
    v_cvt_pk_bf16_f32 v31, v31, v31
    s_nop 1
    v_add_f32_dpp v45, v45, v45 row_half_mirror row_mask:0xf bank_mask:0xf
    v_mov_b32 v41, v45
    s_nop 1
    v_permlane16_swap_b32 v41, v45
    s_nop 0
    v_add_f32 v45, v45, v41
    v_mov_b32 v41, v45
    s_nop 1
    v_permlane32_swap_b32 v41, v45
    s_nop 0
    v_add_f32 v45, v45, v41
    s_waitcnt vmcnt(4)
    s_cmp_eq_u32 s65, 0
    s_cbranch_scc1 L_nt_123
    s_waitcnt vmcnt(3)
L_nt_123:
    s_add_u32 s46, s64, 0x30000
    buffer_load_dwordx4 v[52:55], v3, s[8:11], s46 offen offset:0 nt
    v_readlane_b32 s58, v44, 0
    v_readlane_b32 s59, v44, 8
    s_lshl_b32 s46, s44, 4
    v_add_u32 v5, s46, v1
    s_mov_b64 exec, 0x101
    ds_write_b64 v5, v[44:45] offset:47104
    s_mov_b64 exec, 1
    v_mov_b32 v12, 0
    v_mov_b32 v13, 1
    ds_add_u32 v12, v13 offset:47308
    s_mov_b64 exec, -1
    v_lshrrev_b32 v5, 5, v1
    v_lshlrev_b32 v5, 8, v5
    v_and_b32 v6, 7, v1
    v_lshl_add_u32 v5, v6, 5, v5
    v_and_b32 v6, 16, v1
    v_add_u32 v5, v5, v6
    s_lshl_b32 s46, s44, 9
    v_add_u32 v5, s46, v5
    s_waitcnt lgkmcnt(0)
    v_and_b32 v32, v16, v8
    v_and_b32 v33, v16, v9
    v_and_b32_dpp v34, v16, v10 row_half_mirror row_mask:0xf bank_mask:0xf
    v_and_b32_dpp v35, v16, v11 row_half_mirror row_mask:0xf bank_mask:0xf
    v_and_b32_dpp v36, v16, v8 row_half_mirror row_mask:0xf bank_mask:0xf
    v_and_b32_dpp v37, v16, v9 row_half_mirror row_mask:0xf bank_mask:0xf
    v_and_b32 v38, v16, v10
    v_and_b32 v39, v16, v11
    s_nop 0
    v_mfma_f32_16x16x32_bf16 v[40:43], v[32:35], v[212:215], 0
    v_mfma_f32_16x16x32_bf16 v[44:47], v[36:39], v[212:215], 0
    v_and_b32 v32, v17, v8
    v_and_b32 v33, v17, v9
    v_and_b32_dpp v34, v17, v10 row_half_mirror row_mask:0xf bank_mask:0xf
    v_and_b32_dpp v35, v17, v11 row_half_mirror row_mask:0xf bank_mask:0xf
    v_and_b32_dpp v36, v17, v8 row_half_mirror row_mask:0xf bank_mask:0xf
    v_and_b32_dpp v37, v17, v9 row_half_mirror row_mask:0xf bank_mask:0xf
    v_and_b32 v38, v17, v10
    v_and_b32 v39, v17, v11
    s_nop 0
    v_mfma_f32_16x16x32_bf16 v[40:43], v[32:35], v[216:219], v[40:43]
    v_mfma_f32_16x16x32_bf16 v[44:47], v[36:39], v[216:219], v[44:47]
    s_waitcnt vmcnt(4)
    s_cmp_eq_u32 s65, 0
    s_cbranch_scc1 L_nt_124
    s_waitcnt vmcnt(3)
L_nt_124:
    s_add_u32 s46, s64, 0x30000
    buffer_load_dwordx4 v[56:59], v3, s[8:11], s46 offen offset:2048 nt
    v_and_b32 v32, v18, v8
    v_and_b32 v33, v18, v9
    v_and_b32_dpp v34, v18, v10 row_half_mirror row_mask:0xf bank_mask:0xf
    v_and_b32_dpp v35, v18, v11 row_half_mirror row_mask:0xf bank_mask:0xf
    v_and_b32_dpp v36, v18, v8 row_half_mirror row_mask:0xf bank_mask:0xf
    v_and_b32_dpp v37, v18, v9 row_half_mirror row_mask:0xf bank_mask:0xf
    v_and_b32 v38, v18, v10
    v_and_b32 v39, v18, v11
    s_nop 0
    v_mfma_f32_16x16x32_bf16 v[40:43], v[32:35], v[220:223], v[40:43]
    v_mfma_f32_16x16x32_bf16 v[44:47], v[36:39], v[220:223], v[44:47]
    s_waitcnt vmcnt(4)
    s_cmp_eq_u32 s65, 0
    s_cbranch_scc1 L_nt_125
    s_waitcnt vmcnt(3)
L_nt_125:
    s_add_u32 s46, s64, 0x40000
    buffer_load_dwordx4 v[60:63], v3, s[8:11], s46 offen offset:0 nt
    v_and_b32 v32, v19, v8
    v_and_b32 v33, v19, v9
    v_and_b32_dpp v34, v19, v10 row_half_mirror row_mask:0xf bank_mask:0xf
    v_and_b32_dpp v35, v19, v11 row_half_mirror row_mask:0xf bank_mask:0xf
    v_and_b32_dpp v36, v19, v8 row_half_mirror row_mask:0xf bank_mask:0xf
    v_and_b32_dpp v37, v19, v9 row_half_mirror row_mask:0xf bank_mask:0xf
    v_and_b32 v38, v19, v10
    v_and_b32 v39, v19, v11
    s_nop 0
    v_mfma_f32_16x16x32_bf16 v[40:43], v[32:35], v[224:227], v[40:43]
    v_mfma_f32_16x16x32_bf16 v[44:47], v[36:39], v[224:227], v[44:47]
    s_waitcnt vmcnt(4)
    s_cmp_eq_u32 s65, 0
    s_cbranch_scc1 L_nt_126
    s_waitcnt vmcnt(3)
L_nt_126:
    buffer_load_dwordx4 v[144:147], v4, s[16:19], s72 offen offset:0
    v_and_b32 v32, v20, v8
    v_and_b32 v33, v20, v9
    v_and_b32_dpp v34, v20, v10 row_half_mirror row_mask:0xf bank_mask:0xf
    v_and_b32_dpp v35, v20, v11 row_half_mirror row_mask:0xf bank_mask:0xf
    v_and_b32_dpp v36, v20, v8 row_half_mirror row_mask:0xf bank_mask:0xf
    v_and_b32_dpp v37, v20, v9 row_half_mirror row_mask:0xf bank_mask:0xf
    v_and_b32 v38, v20, v10
    v_and_b32 v39, v20, v11
    s_nop 0
    v_mfma_f32_16x16x32_bf16 v[40:43], v[32:35], v[228:231], v[40:43]
    v_mfma_f32_16x16x32_bf16 v[44:47], v[36:39], v[228:231], v[44:47]
    s_cmp_eq_u32 s101, 1
    s_cselect_b32 s51, s51, 0x40000000
    v_lshlrev_b32 v97, 2, v1
    buffer_load_dwordx4 v[88:91], v0, s[12:15], s51 offen sc1
    buffer_load_dwordx4 v[92:95], v0, s[12:15], s51 offen offset:1024 sc1
    buffer_load_dword v96, v97, s[12:15], s51 offen offset:2048 sc1
    s_waitcnt vmcnt(7)
    s_cmp_eq_u32 s65, 0
    s_cbranch_scc1 L_nt_127
    s_waitcnt vmcnt(6)
L_nt_127:
    s_add_u32 s46, s64, 0x40000
    buffer_load_dwordx4 v[64:67], v3, s[8:11], s46 offen offset:2048 nt
    v_and_b32 v32, v21, v8
    v_and_b32 v33, v21, v9
    v_and_b32_dpp v34, v21, v10 row_half_mirror row_mask:0xf bank_mask:0xf
    v_and_b32_dpp v35, v21, v11 row_half_mirror row_mask:0xf bank_mask:0xf
    v_and_b32_dpp v36, v21, v8 row_half_mirror row_mask:0xf bank_mask:0xf
    v_and_b32_dpp v37, v21, v9 row_half_mirror row_mask:0xf bank_mask:0xf
    v_and_b32 v38, v21, v10
    v_and_b32 v39, v21, v11
    s_nop 0
    v_mfma_f32_16x16x32_bf16 v[40:43], v[32:35], v[48:51], v[40:43]
    v_mfma_f32_16x16x32_bf16 v[44:47], v[36:39], v[48:51], v[44:47]
    s_waitcnt vmcnt(7)
    s_cmp_eq_u32 s65, 0
    s_cbranch_scc1 L_nt_128
    s_waitcnt vmcnt(6)
L_nt_128:
    buffer_load_dwordx4 v[148:151], v4, s[16:19], s73 offen offset:256
    v_and_b32 v32, v22, v8
    v_and_b32 v33, v22, v9
    v_and_b32_dpp v34, v22, v10 row_half_mirror row_mask:0xf bank_mask:0xf
    v_and_b32_dpp v35, v22, v11 row_half_mirror row_mask:0xf bank_mask:0xf
    v_and_b32_dpp v36, v22, v8 row_half_mirror row_mask:0xf bank_mask:0xf
    v_and_b32_dpp v37, v22, v9 row_half_mirror row_mask:0xf bank_mask:0xf
    v_and_b32 v38, v22, v10
    v_and_b32 v39, v22, v11
    s_nop 0
    v_mfma_f32_16x16x32_bf16 v[40:43], v[32:35], v[52:55], v[40:43]
    v_mfma_f32_16x16x32_bf16 v[44:47], v[36:39], v[52:55], v[44:47]
    s_waitcnt vmcnt(7)
    s_cmp_eq_u32 s65, 0
    s_cbranch_scc1 L_nt_129
    s_waitcnt vmcnt(6)
L_nt_129:
    s_add_u32 s46, s64, 0x50000
    buffer_load_dwordx4 v[68:71], v3, s[8:11], s46 offen offset:0 nt
    v_and_b32 v32, v23, v8
    v_and_b32 v33, v23, v9
    v_and_b32_dpp v34, v23, v10 row_half_mirror row_mask:0xf bank_mask:0xf
    v_and_b32_dpp v35, v23, v11 row_half_mirror row_mask:0xf bank_mask:0xf
    v_and_b32_dpp v36, v23, v8 row_half_mirror row_mask:0xf bank_mask:0xf
    v_and_b32_dpp v37, v23, v9 row_half_mirror row_mask:0xf bank_mask:0xf
    v_and_b32 v38, v23, v10
    v_and_b32 v39, v23, v11
    s_nop 0
    v_mfma_f32_16x16x32_bf16 v[40:43], v[32:35], v[56:59], v[40:43]
    v_mfma_f32_16x16x32_bf16 v[44:47], v[36:39], v[56:59], v[44:47]
    s_waitcnt vmcnt(7)
    s_cmp_eq_u32 s65, 0
    s_cbranch_scc1 L_nt_130
    s_waitcnt vmcnt(6)
L_nt_130:
    s_add_u32 s46, s64, 0x50000
    buffer_load_dwordx4 v[72:75], v3, s[8:11], s46 offen offset:2048 nt
    v_and_b32 v32, v24, v8
    v_and_b32 v33, v24, v9
    v_and_b32_dpp v34, v24, v10 row_half_mirror row_mask:0xf bank_mask:0xf
    v_and_b32_dpp v35, v24, v11 row_half_mirror row_mask:0xf bank_mask:0xf
    v_and_b32_dpp v36, v24, v8 row_half_mirror row_mask:0xf bank_mask:0xf
    v_and_b32_dpp v37, v24, v9 row_half_mirror row_mask:0xf bank_mask:0xf
    v_and_b32 v38, v24, v10
    v_and_b32 v39, v24, v11
    s_nop 0
    v_mfma_f32_16x16x32_bf16 v[40:43], v[32:35], v[60:63], v[40:43]
    v_mfma_f32_16x16x32_bf16 v[44:47], v[36:39], v[60:63], v[44:47]
    s_waitcnt vmcnt(7)
    s_cmp_eq_u32 s65, 0
    s_cbranch_scc1 L_nt_131
    s_waitcnt vmcnt(3)
L_nt_131:
    buffer_load_dwordx4 v[152:155], v4, s[16:19], s72 offen offset:512
    s_waitcnt vmcnt(4)
    s_cmp_eq_u32 s65, 0
    s_cbranch_scc1 L_nt_132
    s_waitcnt vmcnt(3)
L_nt_132:
    s_add_u32 s46, s64, 0x60000
    buffer_load_dwordx4 v[76:79], v3, s[8:11], s46 offen offset:0 nt
    s_cmp_eq_u32 s101, 0
    s_cbranch_scc1 L_noy_133
    v_bfe_u32 v98, v1, 3, 2
    v_lshlrev_b32 v98, 3, v98
    v_mov_b32 v99, s40
    v_alignbit_b32 v98, v99, v99, v98
    s_mov_b32 s47, 2000000
L_hp_top_134:
    v_xor_b32 v99, s40, v88
    v_bitop3_b32 v99, v89, s41, v99 bitop3:0xbe
    v_bitop3_b32 v99, v90, s42, v99 bitop3:0xbe
    v_bitop3_b32 v99, v91, s43, v99 bitop3:0xbe
    v_bitop3_b32 v99, v92, s40, v99 bitop3:0xbe
    v_bitop3_b32 v99, v93, s41, v99 bitop3:0xbe
    v_bitop3_b32 v99, v94, s42, v99 bitop3:0xbe
    v_bitop3_b32 v99, v95, s43, v99 bitop3:0xbe
    v_bitop3_b32 v99, v96, v98, v99 bitop3:0xbe
    v_and_b32 v99, 0xffff, v99
    v_cmp_ne_u32 vcc, 0, v99
    s_sub_u32 s47, s47, 1
    s_cbranch_scc1 L_hp_ok_135
    s_nop 2
    s_cbranch_vccz L_hp_ok_135
    buffer_load_dwordx4 v[88:91], v0, s[12:15], s51 offen sc1
    buffer_load_dwordx4 v[92:95], v0, s[12:15], s51 offen offset:1024 sc1
    buffer_load_dword v96, v97, s[12:15], s51 offen offset:2048 sc1
    s_waitcnt vmcnt(0)
    s_branch L_hp_top_134
L_hp_ok_135:
    s_mov_b32 s49, 0x07060302
    v_perm_b32 v140, v89, v88, s49
    v_perm_b32 v141, v91, v90, s49
    v_perm_b32 v142, v93, v92, s49
    v_perm_b32 v143, v95, v94, s49
    v_lshrrev_b32 v96, 16, v96
    s_mov_b32 s48, 0x05040100
    s_mov_b32 s49, 0x07060302
    v_mov_b32 v120, 0
    v_mov_b32 v121, 0
    v_mov_b32 v122, v96
    v_mov_b32 v123, 0
    v_mov_b32 v124, 0
    v_mov_b32 v125, 0
    v_mov_b32 v126, 0
    v_mov_b32 v127, v96
    v_mov_b32 v128, 0
    v_mov_b32 v129, 0
    v_lshlrev_b32 v130, 16, v96
    v_mov_b32 v131, 0
    v_mov_b32 v132, 0
    v_mov_b32 v133, 0
    v_mov_b32 v134, 0
    v_lshlrev_b32 v135, 16, v96
    v_mov_b32 v136, 0
    v_mov_b32 v137, 0
L_noy_133:
    s_cmp_eq_u32 s101, 0
    s_cbranch_scc1 L_noy_136
    s_mov_b32 s48, 0x05040100
    s_mov_b32 s49, 0x07060302
    v_perm_b32 v232, v180, v176, s48
    v_perm_b32 v233, v188, v184, s48
    v_perm_b32 v234, v196, v192, s48
    v_perm_b32 v235, v204, v200, s48
    v_mfma_f32_16x16x32_bf16 v[88:91], v[208:211], v[122:125], 0
    s_nop 0
    v_mfma_f32_16x16x32_bf16 v[88:91], v[232:235], v[140:143], v[88:91]
    v_perm_b32 v236, v180, v176, s49
    v_perm_b32 v237, v188, v184, s49
    v_perm_b32 v238, v196, v192, s49
    v_perm_b32 v239, v204, v200, s49
    v_mfma_f32_16x16x32_bf16 v[92:95], v[208:211], v[130:133], 0
    s_nop 0
    v_mfma_f32_16x16x32_bf16 v[92:95], v[236:239], v[140:143], v[92:95]
    v_perm_b32 v240, v181, v177, s48
    v_perm_b32 v241, v189, v185, s48
    v_perm_b32 v242, v197, v193, s48
    v_perm_b32 v243, v205, v201, s48
    v_mfma_f32_16x16x32_bf16 v[96:99], v[208:211], v[126:129], 0
    s_nop 0
    v_mfma_f32_16x16x32_bf16 v[96:99], v[240:243], v[140:143], v[96:99]
    v_perm_b32 v244, v181, v177, s49
    v_perm_b32 v245, v189, v185, s49
    v_perm_b32 v246, v197, v193, s49
    v_perm_b32 v247, v205, v201, s49
    v_mfma_f32_16x16x32_bf16 v[100:103], v[208:211], v[134:137], 0
    s_nop 0
    v_mfma_f32_16x16x32_bf16 v[100:103], v[244:247], v[140:143], v[100:103]
    v_perm_b32 v232, v182, v178, s48
    v_perm_b32 v233, v190, v186, s48
    v_perm_b32 v234, v198, v194, s48
    v_perm_b32 v235, v206, v202, s48
    v_mfma_f32_16x16x32_bf16 v[104:107], v[208:211], v[120:123], 0
    s_nop 0
    v_mfma_f32_16x16x32_bf16 v[104:107], v[232:235], v[140:143], v[104:107]
    v_perm_b32 v236, v182, v178, s49
    v_perm_b32 v237, v190, v186, s49
    v_perm_b32 v238, v198, v194, s49
    v_perm_b32 v239, v206, v202, s49
    v_mfma_f32_16x16x32_bf16 v[108:111], v[208:211], v[128:131], 0
    s_nop 0
    v_mfma_f32_16x16x32_bf16 v[108:111], v[236:239], v[140:143], v[108:111]
    v_perm_b32 v240, v183, v179, s48
    v_perm_b32 v241, v191, v187, s48
    v_perm_b32 v242, v199, v195, s48
    v_perm_b32 v243, v207, v203, s48
    v_mfma_f32_16x16x32_bf16 v[112:115], v[208:211], v[124:127], 0
    s_nop 0
    v_mfma_f32_16x16x32_bf16 v[112:115], v[240:243], v[140:143], v[112:115]
    v_perm_b32 v244, v183, v179, s49
    v_perm_b32 v245, v191, v187, s49
    v_perm_b32 v246, v199, v195, s49
    v_perm_b32 v247, v207, v203, s49
    v_mfma_f32_16x16x32_bf16 v[116:119], v[208:211], v[132:135], 0
    s_nop 0
    v_mfma_f32_16x16x32_bf16 v[116:119], v[244:247], v[140:143], v[116:119]
    v_lshrrev_b32 v140, 5, v1
    v_mul_u32_u24 v140, 2176, v140
    v_and_b32 v141, 7, v1
    v_mul_u32_u24 v141, 272, v141
    v_add_u32 v140, v140, v141
    v_and_b32 v141, 16, v1
    s_mul_i32 s46, s44, 4352
    v_add3_u32 v140, v140, v141, s46
    s_mov_b32 exec_lo, 0x00ff00ff
    s_mov_b32 exec_hi, 0xff00ff00
    ds_write_b128 v140, v[88:91] offset:0
    ds_write_b128 v140, v[92:95] offset:32
    ds_write_b128 v140, v[96:99] offset:64
    ds_write_b128 v140, v[100:103] offset:96
    ds_write_b128 v140, v[104:107] offset:128
    ds_write_b128 v140, v[108:111] offset:160
    ds_write_b128 v140, v[112:115] offset:192
    ds_write_b128 v140, v[116:119] offset:224
    s_mov_b64 exec, 1
    v_mov_b32 v141, 0
    v_mov_b32 v142, 1
    ds_add_u32 v141, v142 offset:47300
    s_mov_b64 exec, -1
L_noy_136:
    s_load_dwordx2 s[36:37], s[0:1], 80
    s_mov_b32 s38, 0x480
    s_mov_b32 s39, 0x20000
    s_load_dwordx2 s[20:21], s[0:1], 72
    s_mov_b32 s22, 0x480
    s_mov_b32 s23, 0x20000
    s_load_dwordx2 s[32:33], s[0:1], 88
    s_mov_b32 s34, 0x2400
    s_mov_b32 s35, 0x20000
    s_waitcnt vmcnt(4)
    s_cmp_eq_u32 s65, 0
    s_cbranch_scc1 L_nt_137
    s_waitcnt vmcnt(3)
L_nt_137:
    s_add_u32 s46, s64, 0x60000
    buffer_load_dwordx4 v[80:83], v3, s[8:11], s46 offen offset:2048 nt
    v_and_b32 v32, v25, v8
    v_and_b32 v33, v25, v9
    v_and_b32_dpp v34, v25, v10 row_half_mirror row_mask:0xf bank_mask:0xf
    v_and_b32_dpp v35, v25, v11 row_half_mirror row_mask:0xf bank_mask:0xf
    v_and_b32_dpp v36, v25, v8 row_half_mirror row_mask:0xf bank_mask:0xf
    v_and_b32_dpp v37, v25, v9 row_half_mirror row_mask:0xf bank_mask:0xf
    v_and_b32 v38, v25, v10
    v_and_b32 v39, v25, v11
    s_nop 0
    v_mfma_f32_16x16x32_bf16 v[40:43], v[32:35], v[64:67], v[40:43]
    v_mfma_f32_16x16x32_bf16 v[44:47], v[36:39], v[64:67], v[44:47]
    s_waitcnt vmcnt(4)
    s_cmp_eq_u32 s65, 0
    s_cbranch_scc1 L_nt_138
    s_waitcnt vmcnt(3)
L_nt_138:
    buffer_load_dwordx4 v[156:159], v4, s[16:19], s73 offen offset:768
    v_and_b32 v32, v26, v8
    v_and_b32 v33, v26, v9
    v_and_b32_dpp v34, v26, v10 row_half_mirror row_mask:0xf bank_mask:0xf
    v_and_b32_dpp v35, v26, v11 row_half_mirror row_mask:0xf bank_mask:0xf
    v_and_b32_dpp v36, v26, v8 row_half_mirror row_mask:0xf bank_mask:0xf
    v_and_b32_dpp v37, v26, v9 row_half_mirror row_mask:0xf bank_mask:0xf
    v_and_b32 v38, v26, v10
    v_and_b32 v39, v26, v11
    s_nop 0
    v_mfma_f32_16x16x32_bf16 v[40:43], v[32:35], v[68:71], v[40:43]
    v_mfma_f32_16x16x32_bf16 v[44:47], v[36:39], v[68:71], v[44:47]
    v_mov_b32 v240, 0
    v_mov_b32 v241, 0
    v_mov_b32 v242, 0
    v_mov_b32 v243, 0
    v_mov_b32 v244, 0
    v_mov_b32 v245, 0
    v_mov_b32 v246, 0
    v_mov_b32 v247, 0
    s_mul_i32 s46, s55, 1152
    s_lshl_b32 s48, s56, 6
    s_add_u32 s53, s48, s46
    s_mov_b32 s49, 0
    s_cmp_eq_u32 s54, 1
    s_cselect_b32 s46, s46, 0x40000000
    s_cmp_eq_u32 s54, 1
    s_cselect_b32 s48, s48, 0x40000000
    s_cmp_eq_u32 s54, 1
    s_cselect_b32 s49, s49, 0x40000000
    v_and_b32 v249, 7, v1
    v_lshlrev_b32 v249, 3, v249
    v_lshrrev_b32 v250, 4, v1
    v_lshl_add_u32 v249, v250, 1, v249
    s_waitcnt lgkmcnt(0)
    buffer_load_dwordx4 v[232:235], v0, s[24:27], s46 offen
    buffer_load_dwordx4 v[236:239], v0, s[36:39], s49 offen
    s_mov_b64 exec, 0xff
    buffer_load_dwordx4 v[240:243], v0, s[24:27], s46 offen offset:1024
    buffer_load_dwordx4 v[244:247], v0, s[36:39], s49 offen offset:1024
    s_mov_b64 exec, -1
    buffer_load_ushort v250, v249, s[20:23], s48 offen
    s_waitcnt vmcnt(9)
    s_cmp_eq_u32 s65, 0
    s_cbranch_scc1 L_nt_139
    s_waitcnt vmcnt(8)
L_nt_139:
    s_add_u32 s46, s64, 0x70000
    buffer_load_dwordx4 v[84:87], v3, s[8:11], s46 offen offset:0 nt
    v_and_b32 v32, v27, v8
    v_and_b32 v33, v27, v9
    v_and_b32_dpp v34, v27, v10 row_half_mirror row_mask:0xf bank_mask:0xf
    v_and_b32_dpp v35, v27, v11 row_half_mirror row_mask:0xf bank_mask:0xf
    v_and_b32_dpp v36, v27, v8 row_half_mirror row_mask:0xf bank_mask:0xf
    v_and_b32_dpp v37, v27, v9 row_half_mirror row_mask:0xf bank_mask:0xf
    v_and_b32 v38, v27, v10
    v_and_b32 v39, v27, v11
    s_nop 0
    v_mfma_f32_16x16x32_bf16 v[40:43], v[32:35], v[72:75], v[40:43]
    v_mfma_f32_16x16x32_bf16 v[44:47], v[36:39], v[72:75], v[44:47]
    s_cmp_eq_u32 s101, 0
    s_cbranch_scc1 L_noy_140
    v_and_b32 v140, 7, v1
    v_lshlrev_b32 v140, 5, v140
    v_lshrrev_b32 v141, 3, v1
    v_lshl_add_u32 v140, v141, 2, v140
    s_mul_i32 s46, s44, 272
    v_add_u32 v140, s46, v140
    v_and_b32 v141, 3, v1
    v_lshlrev_b32 v141, 3, v141
    v_lshrrev_b32_e64 v141, v141, s40
    s_mov_b32 s47, 32000000
    v_mov_b32 v143, 0
L_uc_top_141:
    ds_read_b32 v142, v143 offset:47300
    s_waitcnt lgkmcnt(0)
    v_readfirstlane_b32 s46, v142
    s_sub_u32 s47, s47, 1
    s_cbranch_scc1 L_uc_ok_142
    s_cmp_lt_u32 s46, 8
    s_cbranch_scc1 L_uc_top_141
L_uc_ok_142:
    ds_read_b32 v88, v140 offset:0
    ds_read_b32 v89, v140 offset:2176
    ds_read_b32 v90, v140 offset:4352
    ds_read_b32 v91, v140 offset:6528
    ds_read_b32 v92, v140 offset:8704
    ds_read_b32 v93, v140 offset:10880
    ds_read_b32 v94, v140 offset:13056
    ds_read_b32 v95, v140 offset:15232
    ds_read_b32 v96, v140 offset:17408
    ds_read_b32 v97, v140 offset:19584
    ds_read_b32 v98, v140 offset:21760
    ds_read_b32 v99, v140 offset:23936
    ds_read_b32 v100, v140 offset:26112
    ds_read_b32 v101, v140 offset:28288
    ds_read_b32 v102, v140 offset:30464
    ds_read_b32 v103, v140 offset:32640
    s_waitcnt lgkmcnt(0)
    v_add_f32 v88, v88, v96
    v_add_f32 v89, v89, v97
    v_add_f32 v90, v90, v98
    v_add_f32 v91, v91, v99
    v_add_f32 v92, v92, v100
    v_add_f32 v93, v93, v101
    v_add_f32 v94, v94, v102
    v_add_f32 v95, v95, v103
    v_add_f32 v88, v88, v92
    v_add_f32 v89, v89, v93
    v_add_f32 v90, v90, v94
    v_add_f32 v91, v91, v95
    v_add_f32 v88, v88, v90
    v_add_f32 v89, v89, v91
    v_add_f32 v88, v88, v89
    v_bfi_b32 v248, v7, v141, v88
L_noy_140:
    s_waitcnt vmcnt(9)
    s_cmp_eq_u32 s65, 0
    s_cbranch_scc1 L_nt_143
    s_waitcnt vmcnt(8)
L_nt_143:
    buffer_load_dwordx4 v[160:163], v4, s[16:19], s72 offen offset:1152
    s_waitcnt vmcnt(9)
    s_cmp_eq_u32 s65, 0
    s_cbranch_scc1 L_nt_144
    s_waitcnt vmcnt(8)
L_nt_144:
    s_add_u32 s46, s64, 0x70000
    buffer_load_dwordx4 v[48:51], v3, s[8:11], s46 offen offset:2048 nt
    v_and_b32 v32, v28, v8
    v_and_b32 v33, v28, v9
    v_and_b32_dpp v34, v28, v10 row_half_mirror row_mask:0xf bank_mask:0xf
    v_and_b32_dpp v35, v28, v11 row_half_mirror row_mask:0xf bank_mask:0xf
    v_and_b32_dpp v36, v28, v8 row_half_mirror row_mask:0xf bank_mask:0xf
    v_and_b32_dpp v37, v28, v9 row_half_mirror row_mask:0xf bank_mask:0xf
    v_and_b32 v38, v28, v10
    v_and_b32 v39, v28, v11
    s_nop 0
    v_mfma_f32_16x16x32_bf16 v[40:43], v[32:35], v[76:79], v[40:43]
    v_mfma_f32_16x16x32_bf16 v[44:47], v[36:39], v[76:79], v[44:47]
    v_and_b32 v6, 7, v1
    v_lshlrev_b32 v6, 4, v6
    v_lshrrev_b32 v252, 5, v1
    v_lshl_add_u32 v6, v252, 3, v6
    s_mov_b32 s47, 32000000
    v_mov_b32 v253, 0
L_sc_top_145:
    ds_read_b32 v252, v253 offset:47308
    s_waitcnt lgkmcnt(0)
    v_readfirstlane_b32 s46, v252
    s_sub_u32 s47, s47, 1
    s_cbranch_scc1 L_sc_ok_146
    s_cmp_lt_u32 s46, 8
    s_cbranch_scc1 L_sc_top_145
L_sc_ok_146:
    ds_read_b64 v[252:253], v6 offset:47104
    s_waitcnt lgkmcnt(0)
    v_mov_b32 v254, v252
    s_nop 1
    v_max_f32_dpp v254, v254, v254 row_half_mirror row_mask:0xf bank_mask:0xf
    s_nop 1
    v_max_f32_dpp v254, v254, v254 quad_perm:[1,0,3,2] row_mask:0xf bank_mask:0xf
    s_nop 1
    v_max_f32_dpp v254, v254, v254 quad_perm:[2,3,0,1] row_mask:0xf bank_mask:0xf
    v_sub_f32 v252, v252, v254
    v_exp_f32 v252, v252
    s_nop 0
    v_mul_f32 v253, v253, v252
    s_nop 1
    v_add_f32_dpp v253, v253, v253 row_half_mirror row_mask:0xf bank_mask:0xf
    s_nop 1
    v_add_f32_dpp v253, v253, v253 quad_perm:[1,0,3,2] row_mask:0xf bank_mask:0xf
    s_nop 1
    v_add_f32_dpp v253, v253, v253 quad_perm:[2,3,0,1] row_mask:0xf bank_mask:0xf
    v_and_b32 v253, 0xffffff00, v253
    v_cmp_gt_u32 vcc, 32, v1
    v_mov_b32 v252, s58
    v_mov_b32 v255, s59
    v_cndmask_b32 v252, v255, v252, vcc
    v_sub_f32 v252, v252, v254
    v_exp_f32 v2, v252
    v_readlane_b32 s58, v254, 0
    v_readlane_b32 s59, v253, 0
    v_readlane_b32 s78, v254, 32
    v_readlane_b32 s79, v253, 32
    s_waitcnt vmcnt(9)
    s_cmp_eq_u32 s65, 0
    s_cbranch_scc1 L_nt_147
    s_waitcnt vmcnt(8)
L_nt_147:
    v_xor_b32 v3, 0x80, v3
    buffer_load_dwordx4 v[52:55], v3, s[8:11], s64 offen offset:0 nt
    v_and_b32 v32, v29, v8
    v_and_b32 v33, v29, v9
    v_and_b32_dpp v34, v29, v10 row_half_mirror row_mask:0xf bank_mask:0xf
    v_and_b32_dpp v35, v29, v11 row_half_mirror row_mask:0xf bank_mask:0xf
    v_and_b32_dpp v36, v29, v8 row_half_mirror row_mask:0xf bank_mask:0xf
    v_and_b32_dpp v37, v29, v9 row_half_mirror row_mask:0xf bank_mask:0xf
    v_and_b32 v38, v29, v10
    v_and_b32 v39, v29, v11
    s_nop 0
    v_mfma_f32_16x16x32_bf16 v[40:43], v[32:35], v[80:83], v[40:43]
    v_mfma_f32_16x16x32_bf16 v[44:47], v[36:39], v[80:83], v[44:47]
    s_waitcnt vmcnt(9)
    s_cmp_eq_u32 s65, 0
    s_cbranch_scc1 L_nt_148
    s_waitcnt vmcnt(3)
L_nt_148:
    buffer_load_dwordx4 v[164:167], v4, s[16:19], s73 offen offset:1408
    s_waitcnt vmcnt(4)
    s_cmp_eq_u32 s65, 0
    s_cbranch_scc1 L_nt_149
    s_waitcnt vmcnt(3)
L_nt_149:
    buffer_load_dwordx4 v[56:59], v3, s[8:11], s64 offen offset:2048 nt
    s_cmp_eq_u32 s54, 0
    s_cbranch_scc1 L_nocons_150
    v_mov_b32 v252, 0
    v_lshlrev_b32 v253, 16, v232
    v_lshlrev_b32 v254, 16, v236
    v_fmac_f32 v252, v253, v254
    v_and_b32 v253, 0xffff0000, v232
    v_and_b32 v254, 0xffff0000, v236
    v_fmac_f32 v252, v253, v254
    v_lshlrev_b32 v253, 16, v233
    v_lshlrev_b32 v254, 16, v237
    v_fmac_f32 v252, v253, v254
    v_and_b32 v253, 0xffff0000, v233
    v_and_b32 v254, 0xffff0000, v237
    v_fmac_f32 v252, v253, v254
    v_lshlrev_b32 v253, 16, v234
    v_lshlrev_b32 v254, 16, v238
    v_fmac_f32 v252, v253, v254
    v_and_b32 v253, 0xffff0000, v234
    v_and_b32 v254, 0xffff0000, v238
    v_fmac_f32 v252, v253, v254
    v_lshlrev_b32 v253, 16, v235
    v_lshlrev_b32 v254, 16, v239
    v_fmac_f32 v252, v253, v254
    v_and_b32 v253, 0xffff0000, v235
    v_and_b32 v254, 0xffff0000, v239
    v_fmac_f32 v252, v253, v254
    v_lshlrev_b32 v253, 16, v240
    v_lshlrev_b32 v254, 16, v244
    v_fmac_f32 v252, v253, v254
    v_and_b32 v253, 0xffff0000, v240
    v_and_b32 v254, 0xffff0000, v244
    v_fmac_f32 v252, v253, v254
    v_lshlrev_b32 v253, 16, v241
    v_lshlrev_b32 v254, 16, v245
    v_fmac_f32 v252, v253, v254
    v_and_b32 v253, 0xffff0000, v241
    v_and_b32 v254, 0xffff0000, v245
    v_fmac_f32 v252, v253, v254
    v_lshlrev_b32 v253, 16, v242
    v_lshlrev_b32 v254, 16, v246
    v_fmac_f32 v252, v253, v254
    v_and_b32 v253, 0xffff0000, v242
    v_and_b32 v254, 0xffff0000, v246
    v_fmac_f32 v252, v253, v254
    v_lshlrev_b32 v253, 16, v243
    v_lshlrev_b32 v254, 16, v247
    v_fmac_f32 v252, v253, v254
    v_and_b32 v253, 0xffff0000, v243
    v_and_b32 v254, 0xffff0000, v247
    v_fmac_f32 v252, v253, v254
    s_nop 1
    v_add_f32_dpp v252, v252, v252 row_ror:8 row_mask:0xf bank_mask:0xf
    s_nop 1
    v_add_f32_dpp v252, v252, v252 row_ror:4 row_mask:0xf bank_mask:0xf
    s_nop 1
    v_add_f32_dpp v252, v252, v252 row_ror:2 row_mask:0xf bank_mask:0xf
    s_nop 1
    v_add_f32_dpp v252, v252, v252 row_ror:1 row_mask:0xf bank_mask:0xf
    v_mov_b32 v253, v252
    s_nop 1
    v_permlane16_swap_b32 v253, v252
    s_nop 0
    v_add_f32 v252, v252, v253
    v_mov_b32 v253, v252
    s_nop 1
    v_permlane32_swap_b32 v253, v252
    s_nop 0
    v_add_f32 v252, v252, v253
    v_mul_f32 v252, 0xbfb8aa3b, v252
    v_exp_f32 v252, v252
    s_nop 0
    v_add_f32 v252, 1.0, v252
    v_rcp_f32 v252, v252
    s_nop 0
    v_readfirstlane_b32 s57, v252
    v_sub_f32 v251, 1.0, v252
    v_lshlrev_b32 v250, 16, v250
    v_mul_f32 v250, v250, v251
L_nocons_150:
    v_and_b32 v32, v30, v8
    v_and_b32 v33, v30, v9
    v_and_b32_dpp v34, v30, v10 row_half_mirror row_mask:0xf bank_mask:0xf
    v_and_b32_dpp v35, v30, v11 row_half_mirror row_mask:0xf bank_mask:0xf
    v_and_b32_dpp v36, v30, v8 row_half_mirror row_mask:0xf bank_mask:0xf
    v_and_b32_dpp v37, v30, v9 row_half_mirror row_mask:0xf bank_mask:0xf
    v_and_b32 v38, v30, v10
    v_and_b32 v39, v30, v11
    s_nop 0
    v_mfma_f32_16x16x32_bf16 v[40:43], v[32:35], v[84:87], v[40:43]
    v_mfma_f32_16x16x32_bf16 v[44:47], v[36:39], v[84:87], v[44:47]
    s_waitcnt vmcnt(4)
    s_cmp_eq_u32 s65, 0
    s_cbranch_scc1 L_nt_151
    s_waitcnt vmcnt(3)
L_nt_151:
    s_add_u32 s46, s64, 0x10000
    buffer_load_dwordx4 v[60:63], v3, s[8:11], s46 offen offset:0 nt
    s_waitcnt vmcnt(4)
    s_cmp_eq_u32 s65, 0
    s_cbranch_scc1 L_nt_152
    s_waitcnt vmcnt(3)
L_nt_152:
    buffer_load_dwordx4 v[168:171], v4, s[16:19], s72 offen offset:1664
    v_and_b32 v32, v31, v8
    v_and_b32 v33, v31, v9
    v_and_b32_dpp v34, v31, v10 row_half_mirror row_mask:0xf bank_mask:0xf
    v_and_b32_dpp v35, v31, v11 row_half_mirror row_mask:0xf bank_mask:0xf
    v_and_b32_dpp v36, v31, v8 row_half_mirror row_mask:0xf bank_mask:0xf
    v_and_b32_dpp v37, v31, v9 row_half_mirror row_mask:0xf bank_mask:0xf
    v_and_b32 v38, v31, v10
    v_and_b32 v39, v31, v11
    s_nop 0
    v_mfma_f32_16x16x32_bf16 v[40:43], v[32:35], v[48:51], v[40:43]
    v_mfma_f32_16x16x32_bf16 v[44:47], v[36:39], v[48:51], v[44:47]
    s_nop 7
    v_add_f32_dpp v12, v44, v40 row_ror:8 row_mask:0xf bank_mask:0xf
    v_add_f32_dpp v13, v45, v41 row_ror:8 row_mask:0xf bank_mask:0xf
    v_add_f32_dpp v14, v46, v42 row_ror:8 row_mask:0xf bank_mask:0xf
    v_add_f32_dpp v15, v47, v43 row_ror:8 row_mask:0xf bank_mask:0xf
    v_mul_f32 v12, v12, v2
    v_mul_f32 v13, v13, v2
    v_mul_f32 v14, v14, v2
    v_mul_f32 v15, v15, v2
    s_mov_b32 exec_lo, 0x00ff00ff
    s_mov_b32 exec_hi, 0x00ff00ff
    ds_write_b128 v5, v[12:15] offset:42496
    s_mov_b64 exec, 1
    v_mov_b32 v252, 0
    v_mov_b32 v253, 1
    ds_add_u32 v252, v253 offset:47312
    s_mov_b64 exec, -1
    s_waitcnt lgkmcnt(0)
    s_waitcnt vmcnt(4)
    s_cmp_eq_u32 s65, 0
    s_cbranch_scc1 L_nt_153
    s_waitcnt vmcnt(3)
L_nt_153:
    s_add_u32 s46, s64, 0x10000
    buffer_load_dwordx4 v[64:67], v3, s[8:11], s46 offen offset:2048 nt
    v_and_b32 v32, v16, v8
    v_and_b32 v33, v16, v9
    v_and_b32_dpp v34, v16, v10 row_half_mirror row_mask:0xf bank_mask:0xf
    v_and_b32_dpp v35, v16, v11 row_half_mirror row_mask:0xf bank_mask:0xf
    v_and_b32_dpp v36, v16, v8 row_half_mirror row_mask:0xf bank_mask:0xf
    v_and_b32_dpp v37, v16, v9 row_half_mirror row_mask:0xf bank_mask:0xf
    v_and_b32 v38, v16, v10
    v_and_b32 v39, v16, v11
    s_nop 0
    v_mfma_f32_16x16x32_bf16 v[40:43], v[32:35], v[52:55], 0
    v_mfma_f32_16x16x32_bf16 v[44:47], v[36:39], v[52:55], 0
    s_waitcnt vmcnt(4)
    s_cmp_eq_u32 s65, 0
    s_cbranch_scc1 L_nt_154
    s_waitcnt vmcnt(3)
L_nt_154:
    buffer_load_dwordx4 v[172:175], v4, s[16:19], s73 offen offset:1920
    s_waitcnt vmcnt(4)
    s_cmp_eq_u32 s65, 0
    s_cbranch_scc1 L_nt_155
    s_waitcnt vmcnt(3)
L_nt_155:
    s_add_u32 s46, s64, 0x20000
    buffer_load_dwordx4 v[68:71], v3, s[8:11], s46 offen offset:0 nt
    v_and_b32 v32, v17, v8
    v_and_b32 v33, v17, v9
    v_and_b32_dpp v34, v17, v10 row_half_mirror row_mask:0xf bank_mask:0xf
    v_and_b32_dpp v35, v17, v11 row_half_mirror row_mask:0xf bank_mask:0xf
    v_and_b32_dpp v36, v17, v8 row_half_mirror row_mask:0xf bank_mask:0xf
    v_and_b32_dpp v37, v17, v9 row_half_mirror row_mask:0xf bank_mask:0xf
    v_and_b32 v38, v17, v10
    v_and_b32 v39, v17, v11
    s_nop 0
    v_mfma_f32_16x16x32_bf16 v[40:43], v[32:35], v[56:59], v[40:43]
    v_mfma_f32_16x16x32_bf16 v[44:47], v[36:39], v[56:59], v[44:47]
    s_cmp_lg_u32 s44, 2
    s_cbranch_scc1 L_only_156
    v_and_b32 v6, 31, v1
    v_lshlrev_b32 v6, 4, v6
    v_lshrrev_b32 v12, 5, v1
    v_lshl_add_u32 v6, v12, 11, v6
    s_mov_b32 s47, 32000000
    v_mov_b32 v13, 0
L_yc_top_157:
    ds_read_b32 v12, v13 offset:47312
    s_waitcnt lgkmcnt(0)
    v_readfirstlane_b32 s46, v12
    s_sub_u32 s47, s47, 1
    s_cbranch_scc1 L_yc_ok_158
    s_cmp_lt_u32 s46, 8
    s_cbranch_scc1 L_yc_top_157
L_yc_ok_158:
    ds_read_b128 v[232:235], v6 offset:42496
    ds_read_b128 v[236:239], v6 offset:43008
    ds_read_b128 v[240:243], v6 offset:43520
    ds_read_b128 v[244:247], v6 offset:44032
    s_waitcnt lgkmcnt(0)
    v_add_f32 v232, v232, v236
    v_add_f32 v240, v240, v244
    v_add_f32 v232, v232, v240
    v_add_f32 v233, v233, v237
    v_add_f32 v241, v241, v245
    v_add_f32 v233, v233, v241
    v_add_f32 v234, v234, v238
    v_add_f32 v242, v242, v246
    v_add_f32 v234, v234, v242
    v_add_f32 v235, v235, v239
    v_add_f32 v243, v243, v247
    v_add_f32 v235, v235, v243
    v_mov_b32 v236, v232
    v_mov_b32 v237, v233
    v_mov_b32 v238, v234
    v_mov_b32 v239, v235
    s_nop 0
    v_permlane32_swap_b32 v236, v232
    v_permlane32_swap_b32 v237, v233
    v_permlane32_swap_b32 v238, v234
    v_permlane32_swap_b32 v239, v235
    s_nop 0
    v_add_f32 v12, v232, v236
    v_add_f32 v13, v233, v237
    v_add_f32 v14, v234, v238
    v_add_f32 v15, v235, v239
    v_writelane_b32 v12, s58, 32
    v_writelane_b32 v13, s59, 32
    v_writelane_b32 v14, s78, 32
    v_writelane_b32 v15, s79, 32
    s_lshl_b32 s46, s58, 8
    v_writelane_b32 v12, s46, 33
    s_lshl_b32 s46, s78, 8
    v_writelane_b32 v14, s46, 33
    v_bfi_b32 v12, v7, s28, v12
    v_bfi_b32 v13, v7, s29, v13
    v_bfi_b32 v14, v7, s30, v14
    v_bfi_b32 v15, v7, s31, v15
L_only_156:
    s_mov_b32 s46, s74
    s_cmp_eq_u32 s44, 2
    s_cselect_b32 s46, s46, 0x40000000
    s_mov_b32 exec_hi, 0xff
    s_cmp_eq_u32 s3, 1
    s_cbranch_scc1 L_stl_159
    buffer_store_dwordx4 v[12:15], v0, s[12:15], s46 offen offset:2304 sc1
    s_branch L_std_160
L_stl_159:
    buffer_store_dwordx4 v[12:15], v0, s[12:15], s46 offen offset:2304
L_std_160:
    s_mov_b64 exec, -1
    s_waitcnt vmcnt(5)
    s_cmp_eq_u32 s65, 0
    s_cbranch_scc1 L_nt_161
    s_waitcnt vmcnt(4)
L_nt_161:
    s_add_u32 s46, s64, 0x20000
    buffer_load_dwordx4 v[72:75], v3, s[8:11], s46 offen offset:2048 nt
    v_and_b32 v32, v18, v8
    v_and_b32 v33, v18, v9
    v_and_b32_dpp v34, v18, v10 row_half_mirror row_mask:0xf bank_mask:0xf
    v_and_b32_dpp v35, v18, v11 row_half_mirror row_mask:0xf bank_mask:0xf
    v_and_b32_dpp v36, v18, v8 row_half_mirror row_mask:0xf bank_mask:0xf
    v_and_b32_dpp v37, v18, v9 row_half_mirror row_mask:0xf bank_mask:0xf
    v_and_b32 v38, v18, v10
    v_and_b32 v39, v18, v11
    s_nop 0
    v_mfma_f32_16x16x32_bf16 v[40:43], v[32:35], v[60:63], v[40:43]
    v_mfma_f32_16x16x32_bf16 v[44:47], v[36:39], v[60:63], v[44:47]
    s_waitcnt vmcnt(5)
    s_cmp_eq_u32 s65, 0
    s_cbranch_scc1 L_nt_162
    s_waitcnt vmcnt(4)
L_nt_162:
    buffer_load_dwordx4 v[88:91], v4, s[16:19], s73 offen offset:0
    s_waitcnt vmcnt(5)
    s_cmp_eq_u32 s65, 0
    s_cbranch_scc1 L_nt_163
    s_waitcnt vmcnt(4)
L_nt_163:
    s_add_u32 s46, s64, 0x30000
    buffer_load_dwordx4 v[76:79], v3, s[8:11], s46 offen offset:0 nt
    v_and_b32 v32, v19, v8
    v_and_b32 v33, v19, v9
    v_and_b32_dpp v34, v19, v10 row_half_mirror row_mask:0xf bank_mask:0xf
    v_and_b32_dpp v35, v19, v11 row_half_mirror row_mask:0xf bank_mask:0xf
    v_and_b32_dpp v36, v19, v8 row_half_mirror row_mask:0xf bank_mask:0xf
    v_and_b32_dpp v37, v19, v9 row_half_mirror row_mask:0xf bank_mask:0xf
    v_and_b32 v38, v19, v10
    v_and_b32 v39, v19, v11
    s_nop 0
    v_mfma_f32_16x16x32_bf16 v[40:43], v[32:35], v[64:67], v[40:43]
    v_mfma_f32_16x16x32_bf16 v[44:47], v[36:39], v[64:67], v[44:47]
    s_waitcnt vmcnt(5)
    s_cmp_eq_u32 s65, 0
    s_cbranch_scc1 L_nt_164
    s_waitcnt vmcnt(4)
L_nt_164:
    s_add_u32 s46, s64, 0x30000
    buffer_load_dwordx4 v[80:83], v3, s[8:11], s46 offen offset:2048 nt
    s_waitcnt vmcnt(5)
    s_cmp_eq_u32 s65, 0
    s_cbranch_scc1 L_nt_165
    s_waitcnt vmcnt(3)
L_nt_165:
    buffer_load_dwordx4 v[92:95], v4, s[16:19], s72 offen offset:256
    v_and_b32 v32, v20, v8
    v_and_b32 v33, v20, v9
    v_and_b32_dpp v34, v20, v10 row_half_mirror row_mask:0xf bank_mask:0xf
    v_and_b32_dpp v35, v20, v11 row_half_mirror row_mask:0xf bank_mask:0xf
    v_and_b32_dpp v36, v20, v8 row_half_mirror row_mask:0xf bank_mask:0xf
    v_and_b32_dpp v37, v20, v9 row_half_mirror row_mask:0xf bank_mask:0xf
    v_and_b32 v38, v20, v10
    v_and_b32 v39, v20, v11
    s_nop 0
    v_mfma_f32_16x16x32_bf16 v[40:43], v[32:35], v[68:71], v[40:43]
    v_mfma_f32_16x16x32_bf16 v[44:47], v[36:39], v[68:71], v[44:47]
    v_mov_b32 v192, 0
    v_mov_b32 v193, 0
    v_mov_b32 v194, 0
    v_mov_b32 v195, 0
    v_mov_b32 v196, 0
    v_mov_b32 v197, 0
    v_mov_b32 v198, 0
    v_mov_b32 v199, 0
    v_mov_b32 v200, 0
    v_mov_b32 v201, 0
    v_mov_b32 v202, 0
    v_mov_b32 v203, 0
    v_mov_b32 v204, 0
    v_mov_b32 v205, 0
    v_mov_b32 v206, 0
    v_mov_b32 v207, 0
    v_lshrrev_b32 v216, 5, v1
    v_lshlrev_b32 v216, 1, v216
    v_bfe_u32 v217, v1, 2, 2
    v_cmp_eq_u32 vcc, v216, v217
    v_and_b32 v210, 3, v1
    v_mul_u32_u24 v210, 0x5555, v210
    v_cndmask_b32_e64 v208, 0, -1, vcc
    v_xor_b32 v217, 1, v217
    v_cmp_eq_u32 vcc, v216, v217
    v_and_b32 v211, 7, v1
    v_xor_b32 v211, v211, v216
    v_cndmask_b32_e64 v209, 0, -1, vcc
    v_bfe_u32 v217, v1, 4, 1
    v_lshl_add_u32 v211, v217, 3, v211
    v_lshlrev_b32 v211, 2, v211
    s_lshl_b32 s46, s44, 6
    s_add_u32 s46, s46, 37376
    v_add_u32 v211, s46, v211
    v_and_b32 v218, 8, v1
    v_lshl_add_u32 v218, v218, 8, v211
    s_mul_i32 s46, s44, 3072
    v_add_u32 v212, s46, v0
    v_lshrrev_b32 v216, 5, v1
    v_mul_u32_u24 v213, 3072, v216
    v_lshl_add_u32 v213, v217, 7, v213
    v_and_b32 v217, 7, v1
    v_lshl_add_u32 v213, v217, 4, v213
    s_and_b32 s46, s44, 1
    s_mul_i32 s46, s46, 6144
    s_lshr_b32 s47, s44, 1
    s_lshl_b32 s47, s47, 8
    s_add_u32 s46, s46, s47
    v_add_u32 v213, s46, v213
    s_cmp_eq_u32 s44, 4
    s_cbranch_scc1 L_red4_166
    v_mul_u32_u24 v214, 11776, v216
    v_add_u32 v214, v214, v0
    s_lshl_b32 s46, s44, 9
    v_add_u32 v214, s46, v214
    v_and_b32 v215, 15, v1
    v_lshlrev_b32 v215, 5, v215
    v_lshl_add_u32 v215, v216, 3, v215
    v_lshlrev_b32 v219, 4, v216
    v_lshrrev_b32_e64 v219, v219, s40
    v_lshrrev_b32 v220, 8, v219
    v_and_b32 v216, 16, v1
    v_add3_u32 v215, v215, v216, s46
    s_branch L_redd_167
L_red4_166:
    v_add_u32 v214, 0x800, v0
    v_lshlrev_b32 v215, 5, v217
    v_and_b32 v216, 8, v1
    v_lshl_add_u32 v215, v216, 1, v215
    v_add_u32 v215, 0x800, v215
    v_lshrrev_b32 v216, 4, v1
    v_lshl_add_u32 v215, v216, 2, v215
    v_lshlrev_b32 v219, 3, v216
    v_lshrrev_b32_e64 v219, v219, s40
L_redd_167:
    v_lshrrev_b32 v216, 3, v1
    v_and_b32 v217, 7, v1
    v_mul_u32_u24 v221, 3328, v216
    v_lshl_add_u32 v221, v217, 4, v221
    v_mul_u32_u24 v222, 2304, v216
    v_lshl_add_u32 v222, v217, 4, v222
    s_mul_i32 s66, s55, 106496
    s_lshl_b32 s46, s56, 7
    s_add_u32 s66, s66, s46
    s_add_u32 s66, s66, 622592
    s_cmp_eq_u32 s54, 1
    s_cselect_b32 s66, s66, 0x40000000
    s_add_u32 s67, s66, 26624
    s_add_u32 s68, s67, 26624
    s_add_u32 s69, s68, 26624
    s_mul_i32 s70, s55, 18432
    s_add_u32 s70, s70, s46
    s_add_u32 s70, s70, 425984
    s_cmp_eq_u32 s54, 1
    s_cselect_b32 s70, s70, 0x40000000
    s_waitcnt vmcnt(4)
    s_cmp_eq_u32 s65, 0
    s_cbranch_scc1 L_nt_168
    s_waitcnt vmcnt(3)
L_nt_168:
    s_add_u32 s46, s64, 0x40000
    buffer_load_dwordx4 v[84:87], v3, s[8:11], s46 offen offset:0 nt
    v_and_b32 v32, v21, v8
    v_and_b32 v33, v21, v9
    v_and_b32_dpp v34, v21, v10 row_half_mirror row_mask:0xf bank_mask:0xf
    v_and_b32_dpp v35, v21, v11 row_half_mirror row_mask:0xf bank_mask:0xf
    v_and_b32_dpp v36, v21, v8 row_half_mirror row_mask:0xf bank_mask:0xf
    v_and_b32_dpp v37, v21, v9 row_half_mirror row_mask:0xf bank_mask:0xf
    v_and_b32 v38, v21, v10
    v_and_b32 v39, v21, v11
    s_nop 0
    v_mfma_f32_16x16x32_bf16 v[40:43], v[32:35], v[72:75], v[40:43]
    v_mfma_f32_16x16x32_bf16 v[44:47], v[36:39], v[72:75], v[44:47]
    s_waitcnt vmcnt(4)
    s_cmp_eq_u32 s65, 0
    s_cbranch_scc1 L_nt_169
    s_waitcnt vmcnt(3)
L_nt_169:
    buffer_load_dwordx4 v[96:99], v4, s[16:19], s73 offen offset:512
    s_waitcnt vmcnt(4)
    s_cmp_eq_u32 s65, 0
    s_cbranch_scc1 L_nt_170
    s_waitcnt vmcnt(3)
L_nt_170:
    s_add_u32 s46, s64, 0x40000
    buffer_load_dwordx4 v[48:51], v3, s[8:11], s46 offen offset:2048 nt
    v_and_b32 v32, v22, v8
    v_and_b32 v33, v22, v9
    v_and_b32_dpp v34, v22, v10 row_half_mirror row_mask:0xf bank_mask:0xf
    v_and_b32_dpp v35, v22, v11 row_half_mirror row_mask:0xf bank_mask:0xf
    v_and_b32_dpp v36, v22, v8 row_half_mirror row_mask:0xf bank_mask:0xf
    v_and_b32_dpp v37, v22, v9 row_half_mirror row_mask:0xf bank_mask:0xf
    v_and_b32 v38, v22, v10
    v_and_b32 v39, v22, v11
    s_nop 0
    v_mfma_f32_16x16x32_bf16 v[40:43], v[32:35], v[76:79], v[40:43]
    v_mfma_f32_16x16x32_bf16 v[44:47], v[36:39], v[76:79], v[44:47]
    s_waitcnt vmcnt(4)
    s_cmp_eq_u32 s65, 0
    s_cbranch_scc1 L_nt_171
    s_waitcnt vmcnt(3)
L_nt_171:
    s_add_u32 s46, s64, 0x50000
    buffer_load_dwordx4 v[52:55], v3, s[8:11], s46 offen offset:0 nt
    v_and_b32 v32, v23, v8
    v_and_b32 v33, v23, v9
    v_and_b32_dpp v34, v23, v10 row_half_mirror row_mask:0xf bank_mask:0xf
    v_and_b32_dpp v35, v23, v11 row_half_mirror row_mask:0xf bank_mask:0xf
    v_and_b32_dpp v36, v23, v8 row_half_mirror row_mask:0xf bank_mask:0xf
    v_and_b32_dpp v37, v23, v9 row_half_mirror row_mask:0xf bank_mask:0xf
    v_and_b32 v38, v23, v10
    v_and_b32 v39, v23, v11
    s_nop 0
    v_mfma_f32_16x16x32_bf16 v[40:43], v[32:35], v[80:83], v[40:43]
    v_mfma_f32_16x16x32_bf16 v[44:47], v[36:39], v[80:83], v[44:47]
    s_waitcnt vmcnt(4)
    s_cmp_eq_u32 s65, 0
    s_cbranch_scc1 L_nt_172
    s_waitcnt vmcnt(3)
L_nt_172:
    buffer_load_dwordx4 v[100:103], v4, s[16:19], s72 offen offset:768
    s_waitcnt vmcnt(4)
    s_cmp_eq_u32 s65, 0
    s_cbranch_scc1 L_nt_173
    s_waitcnt vmcnt(3)
L_nt_173:
    s_add_u32 s46, s64, 0x50000
    buffer_load_dwordx4 v[56:59], v3, s[8:11], s46 offen offset:2048 nt
    v_and_b32 v32, v24, v8
    v_and_b32 v33, v24, v9
    v_and_b32_dpp v34, v24, v10 row_half_mirror row_mask:0xf bank_mask:0xf
    v_and_b32_dpp v35, v24, v11 row_half_mirror row_mask:0xf bank_mask:0xf
    v_and_b32_dpp v36, v24, v8 row_half_mirror row_mask:0xf bank_mask:0xf
    v_and_b32_dpp v37, v24, v9 row_half_mirror row_mask:0xf bank_mask:0xf
    v_and_b32 v38, v24, v10
    v_and_b32 v39, v24, v11
    s_nop 0
    v_mfma_f32_16x16x32_bf16 v[40:43], v[32:35], v[84:87], v[40:43]
    v_mfma_f32_16x16x32_bf16 v[44:47], v[36:39], v[84:87], v[44:47]
    v_min_u32 v6, 0x210, v0
    s_cmp_eq_u32 s44, 3
    s_cselect_b32 s77, s77, 0x40000000
    buffer_load_dwordx4 v[12:15], v6, s[12:15], s77 offen offset:2304 sc1
    s_waitcnt vmcnt(5)
    s_cmp_eq_u32 s65, 0
    s_cbranch_scc1 L_nt_174
    s_waitcnt vmcnt(4)
L_nt_174:
    s_add_u32 s46, s64, 0x60000
    buffer_load_dwordx4 v[60:63], v3, s[8:11], s46 offen offset:0 nt
    s_waitcnt vmcnt(5)
    s_cmp_eq_u32 s65, 0
    s_cbranch_scc1 L_nt_175
    s_waitcnt vmcnt(4)
L_nt_175:
    buffer_load_dwordx4 v[104:107], v4, s[16:19], s73 offen offset:1152
    v_and_b32 v32, v25, v8
    v_and_b32 v33, v25, v9
    v_and_b32_dpp v34, v25, v10 row_half_mirror row_mask:0xf bank_mask:0xf
    v_and_b32_dpp v35, v25, v11 row_half_mirror row_mask:0xf bank_mask:0xf
    v_and_b32_dpp v36, v25, v8 row_half_mirror row_mask:0xf bank_mask:0xf
    v_and_b32_dpp v37, v25, v9 row_half_mirror row_mask:0xf bank_mask:0xf
    v_and_b32 v38, v25, v10
    v_and_b32 v39, v25, v11
    s_nop 0
    v_mfma_f32_16x16x32_bf16 v[40:43], v[32:35], v[48:51], v[40:43]
    v_mfma_f32_16x16x32_bf16 v[44:47], v[36:39], v[48:51], v[44:47]
    s_waitcnt vmcnt(5)
    s_cmp_eq_u32 s65, 0
    s_cbranch_scc1 L_nt_176
    s_waitcnt vmcnt(4)
L_nt_176:
    s_add_u32 s46, s64, 0x60000
    buffer_load_dwordx4 v[64:67], v3, s[8:11], s46 offen offset:2048 nt
    v_and_b32 v32, v26, v8
    v_and_b32 v33, v26, v9
    v_and_b32_dpp v34, v26, v10 row_half_mirror row_mask:0xf bank_mask:0xf
    v_and_b32_dpp v35, v26, v11 row_half_mirror row_mask:0xf bank_mask:0xf
    v_and_b32_dpp v36, v26, v8 row_half_mirror row_mask:0xf bank_mask:0xf
    v_and_b32_dpp v37, v26, v9 row_half_mirror row_mask:0xf bank_mask:0xf
    v_and_b32 v38, v26, v10
    v_and_b32 v39, v26, v11
    s_nop 0
    v_mfma_f32_16x16x32_bf16 v[40:43], v[32:35], v[52:55], v[40:43]
    v_mfma_f32_16x16x32_bf16 v[44:47], v[36:39], v[52:55], v[44:47]
    s_waitcnt vmcnt(5)
    s_cmp_eq_u32 s65, 0
    s_cbranch_scc1 L_nt_177
    s_waitcnt vmcnt(4)
L_nt_177:
    s_add_u32 s46, s64, 0x70000
    buffer_load_dwordx4 v[68:71], v3, s[8:11], s46 offen offset:0 nt
    s_waitcnt vmcnt(5)
    s_cmp_eq_u32 s65, 0
    s_cbranch_scc1 L_nt_178
    s_waitcnt vmcnt(3)
L_nt_178:
    buffer_load_dwordx4 v[108:111], v4, s[16:19], s72 offen offset:1408
    v_and_b32 v32, v27, v8
    v_and_b32 v33, v27, v9
    v_and_b32_dpp v34, v27, v10 row_half_mirror row_mask:0xf bank_mask:0xf
    v_and_b32_dpp v35, v27, v11 row_half_mirror row_mask:0xf bank_mask:0xf
    v_and_b32_dpp v36, v27, v8 row_half_mirror row_mask:0xf bank_mask:0xf
    v_and_b32_dpp v37, v27, v9 row_half_mirror row_mask:0xf bank_mask:0xf
    v_and_b32 v38, v27, v10
    v_and_b32 v39, v27, v11
    s_nop 0
    v_mfma_f32_16x16x32_bf16 v[40:43], v[32:35], v[56:59], v[40:43]
    v_mfma_f32_16x16x32_bf16 v[44:47], v[36:39], v[56:59], v[44:47]
    s_waitcnt vmcnt(4)
    s_add_u32 s46, s64, 0x70000
    buffer_load_dwordx4 v[72:75], v3, s[8:11], s46 offen offset:2048 nt
    v_and_b32 v32, v28, v8
    v_and_b32 v33, v28, v9
    v_and_b32_dpp v34, v28, v10 row_half_mirror row_mask:0xf bank_mask:0xf
    v_and_b32_dpp v35, v28, v11 row_half_mirror row_mask:0xf bank_mask:0xf
    v_and_b32_dpp v36, v28, v8 row_half_mirror row_mask:0xf bank_mask:0xf
    v_and_b32_dpp v37, v28, v9 row_half_mirror row_mask:0xf bank_mask:0xf
    v_and_b32 v38, v28, v10
    v_and_b32 v39, v28, v11
    s_nop 0
    v_mfma_f32_16x16x32_bf16 v[40:43], v[32:35], v[60:63], v[40:43]
    v_mfma_f32_16x16x32_bf16 v[44:47], v[36:39], v[60:63], v[44:47]
    s_cmp_lg_u32 s44, 3
    s_cbranch_scc1 L_only_179
    s_mov_b32 s47, 2000000
L_pk_top_180:
    v_xor_b32 v12, s28, v12
    v_xor_b32 v13, s29, v13
    v_xor_b32 v14, s30, v14
    v_xor_b32 v15, s31, v15
    v_or_b32 v232, v12, v13
    v_or3_b32 v232, v232, v14, v15
    v_and_b32 v232, 0xff, v232
    v_cmp_ne_u32 vcc, 0, v232
    s_sub_u32 s47, s47, 1
    s_cbranch_scc1 L_pk_ok_181
    s_nop 2
    s_cbranch_vccz L_pk_ok_181
    buffer_load_dwordx4 v[12:15], v6, s[12:15], s77 offen offset:2304 sc1
    s_waitcnt vmcnt(0)
    s_branch L_pk_top_180
L_pk_ok_181:
    v_readlane_b32 s48, v12, 32
    v_readlane_b32 s49, v13, 32
    v_readlane_b32 s50, v14, 32
    v_readlane_b32 s51, v15, 32
    v_readlane_b32 s46, v12, 33
    s_bfe_u32 s46, s46, 0x80008
    s_or_b32 s48, s48, s46
    v_readlane_b32 s46, v14, 33
    s_bfe_u32 s46, s46, 0x80008
    s_or_b32 s50, s50, s46
    v_cmp_gt_u32 vcc, 16, v1
    v_mov_b32 v236, s58
    v_mov_b32 v232, s78
    v_cndmask_b32 v236, v232, v236, vcc
    v_mov_b32 v237, s59
    v_mov_b32 v232, s79
    v_cndmask_b32 v237, v232, v237, vcc
    v_mov_b32 v238, s48
    v_mov_b32 v232, s50
    v_cndmask_b32 v238, v232, v238, vcc
    v_mov_b32 v239, s49
    v_mov_b32 v232, s51
    v_cndmask_b32 v239, v232, v239, vcc
    v_max_f32 v232, v236, v238
    v_sub_f32 v236, v236, v232
    v_sub_f32 v238, v238, v232
    v_exp_f32 v236, v236
    v_exp_f32 v238, v238
    s_nop 0
    v_mul_f32 v237, v237, v236
    v_fmac_f32 v237, v239, v238
    v_rcp_f32 v237, v237
    s_nop 0
    v_mul_f32 v236, v236, v237
    v_mul_f32 v238, v238, v237
    v_mul_f32 v12, v12, v238
    v_mul_f32 v13, v13, v238
    v_mul_f32 v14, v14, v238
    v_mul_f32 v15, v15, v238
    v_mov_b32 v237, v236
    v_mov_b32 v238, v236
    v_mov_b32 v239, v236
    s_mov_b32 exec_hi, 0
    ds_write_b128 v0, v[12:15] offset:41472
    ds_write_b128 v0, v[236:239] offset:41984
    s_mov_b64 exec, -1
    s_waitcnt lgkmcnt(0)
L_only_179:
    s_waitcnt vmcnt(4)
    buffer_load_dwordx4 v[112:115], v4, s[16:19], s73 offen offset:1664
    s_waitcnt vmcnt(4)
    buffer_load_dwordx4 v[116:119], v4, s[16:19], s72 offen offset:1920
    v_and_b32 v32, v29, v8
    v_and_b32 v33, v29, v9
    v_and_b32_dpp v34, v29, v10 row_half_mirror row_mask:0xf bank_mask:0xf
    v_and_b32_dpp v35, v29, v11 row_half_mirror row_mask:0xf bank_mask:0xf
    v_and_b32_dpp v36, v29, v8 row_half_mirror row_mask:0xf bank_mask:0xf
    v_and_b32_dpp v37, v29, v9 row_half_mirror row_mask:0xf bank_mask:0xf
    v_and_b32 v38, v29, v10
    v_and_b32 v39, v29, v11
    s_nop 0
    v_mfma_f32_16x16x32_bf16 v[40:43], v[32:35], v[64:67], v[40:43]
    v_mfma_f32_16x16x32_bf16 v[44:47], v[36:39], v[64:67], v[44:47]
    s_waitcnt vmcnt(4)
    v_bfe_u32 v252, v1, 3, 1
    v_lshl_add_u32 v4, v252, 10, v4
    buffer_load_dwordx4 v[120:123], v4, s[16:19], s72 offen offset:1024
    v_and_b32 v32, v30, v8
    v_and_b32 v33, v30, v9
    v_and_b32_dpp v34, v30, v10 row_half_mirror row_mask:0xf bank_mask:0xf
    v_and_b32_dpp v35, v30, v11 row_half_mirror row_mask:0xf bank_mask:0xf
    v_and_b32_dpp v36, v30, v8 row_half_mirror row_mask:0xf bank_mask:0xf
    v_and_b32_dpp v37, v30, v9 row_half_mirror row_mask:0xf bank_mask:0xf
    v_and_b32 v38, v30, v10
    v_and_b32 v39, v30, v11
    s_nop 0
    v_mfma_f32_16x16x32_bf16 v[40:43], v[32:35], v[68:71], v[40:43]
    v_mfma_f32_16x16x32_bf16 v[44:47], v[36:39], v[68:71], v[44:47]
    s_waitcnt vmcnt(4)
    buffer_load_dwordx4 v[124:127], v4, s[16:19], s72 offen offset:3328
    buffer_load_dwordx4 v[176:179], v221, s[12:15], s66 offen sc1
    buffer_load_dwordx4 v[180:183], v221, s[12:15], s67 offen sc1
    buffer_load_dwordx4 v[184:187], v221, s[12:15], s68 offen sc1
    buffer_load_dwordx4 v[188:191], v221, s[12:15], s69 offen sc1
    buffer_load_dwordx4 v[224:227], v222, s[12:15], s70 offen sc1
    v_and_b32 v32, v31, v8
    v_and_b32 v33, v31, v9
    v_and_b32_dpp v34, v31, v10 row_half_mirror row_mask:0xf bank_mask:0xf
    v_and_b32_dpp v35, v31, v11 row_half_mirror row_mask:0xf bank_mask:0xf
    v_and_b32_dpp v36, v31, v8 row_half_mirror row_mask:0xf bank_mask:0xf
    v_and_b32_dpp v37, v31, v9 row_half_mirror row_mask:0xf bank_mask:0xf
    v_and_b32 v38, v31, v10
    v_and_b32 v39, v31, v11
    s_waitcnt vmcnt(9)
    v_mfma_f32_16x16x32_bf16 v[40:43], v[32:35], v[72:75], v[40:43]
    v_mfma_f32_16x16x32_bf16 v[44:47], v[36:39], v[72:75], v[44:47]
    v_lshlrev_b32 v6, 2, v1
    s_mov_b32 s48, 0x00ff00ff
    s_mov_b32 s49, 0xff00ff00
    s_cmp_eq_u32 s101, 1
    s_cselect_b32 s45, s45, 0x40000000
    s_nop 2
    v_add_f32_dpp v40, v44, v40 row_ror:8 row_mask:0xf bank_mask:0xf
    v_add_f32_dpp v41, v45, v41 row_ror:8 row_mask:0xf bank_mask:0xf
    v_add_f32_dpp v42, v46, v42 row_ror:8 row_mask:0xf bank_mask:0xf
    v_add_f32_dpp v43, v47, v43 row_ror:8 row_mask:0xf bank_mask:0xf
    v_mul_f32 v40, v40, v2
    v_mul_f32 v41, v41, v2
    v_mul_f32 v42, v42, v2
    v_mul_f32 v43, v43, v2
    s_mov_b32 exec_lo, 0x00ff00ff
    s_mov_b32 exec_hi, 0x00ff00ff
    ds_write_b128 v5, v[40:43] offset:37376
    s_mov_b64 exec, -1
    buffer_store_dword v248, v6, s[12:15], s45 offen sc1
    s_waitcnt lgkmcnt(0)
    s_barrier
    ds_read2st64_b32 v[12:13], v218 offset0:0 offset1:2
    ds_read2st64_b32 v[14:15], v218 offset0:4 offset1:6
    ds_read2st64_b32 v[16:17], v211 offset0:16 offset1:18
    s_waitcnt lgkmcnt(1)
    v_pk_add_f32 v[12:13], v[12:13], v[14:15]
    v_add_f32 v12, v12, v13
    s_waitcnt lgkmcnt(0)
    s_nop 0
    v_add_f32_dpp v12, v12, v12 row_ror:8 row_mask:0xf bank_mask:0xf
    v_fma_f32 v12, v12, v17, v16
    v_cvt_pk_bf16_f32 v12, v12, 0
    s_nop 1
    v_and_b32_dpp v16, v12, v208 row_newbcast:0 row_mask:0xf bank_mask:0xf
    v_and_b32_dpp v17, v12, v209 row_newbcast:0 row_mask:0xf bank_mask:0xf
    v_and_b32_dpp v18, v12, v208 row_newbcast:4 row_mask:0xf bank_mask:0xf
    v_and_b32_dpp v19, v12, v209 row_newbcast:4 row_mask:0xf bank_mask:0xf
    v_and_b32_dpp v20, v12, v208 row_newbcast:1 row_mask:0xf bank_mask:0xf
    v_and_b32_dpp v21, v12, v209 row_newbcast:1 row_mask:0xf bank_mask:0xf
    v_and_b32_dpp v22, v12, v208 row_newbcast:5 row_mask:0xf bank_mask:0xf
    v_and_b32_dpp v23, v12, v209 row_newbcast:5 row_mask:0xf bank_mask:0xf
    v_smfmac_f32_16x16x64_bf16 v[192:195], v[16:19], v[144:151], v210
    v_smfmac_f32_16x16x64_bf16 v[196:199], v[16:19], v[152:159], v210
    v_and_b32_dpp v24, v12, v208 row_newbcast:2 row_mask:0xf bank_mask:0xf
    v_and_b32_dpp v25, v12, v209 row_newbcast:2 row_mask:0xf bank_mask:0xf
    v_and_b32_dpp v26, v12, v208 row_newbcast:6 row_mask:0xf bank_mask:0xf
    v_and_b32_dpp v27, v12, v209 row_newbcast:6 row_mask:0xf bank_mask:0xf
    v_smfmac_f32_16x16x64_bf16 v[192:195], v[20:23], v[160:167], v210
    v_smfmac_f32_16x16x64_bf16 v[196:199], v[20:23], v[168:175], v210
    v_and_b32_dpp v28, v12, v208 row_newbcast:3 row_mask:0xf bank_mask:0xf
    v_and_b32_dpp v29, v12, v209 row_newbcast:3 row_mask:0xf bank_mask:0xf
    v_and_b32_dpp v30, v12, v208 row_newbcast:7 row_mask:0xf bank_mask:0xf
    v_and_b32_dpp v31, v12, v209 row_newbcast:7 row_mask:0xf bank_mask:0xf
    v_smfmac_f32_16x16x64_bf16 v[192:195], v[24:27], v[88:95], v210
    v_smfmac_f32_16x16x64_bf16 v[196:199], v[24:27], v[96:103], v210
    v_mov_b32_dpp v204, v12 row_newbcast:0 row_mask:0xf bank_mask:0x1
    v_mov_b32_dpp v204, v12 row_newbcast:1 row_mask:0xf bank_mask:0x4
    v_mov_b32_dpp v205, v12 row_newbcast:0 row_mask:0xf bank_mask:0x2
    v_mov_b32_dpp v205, v12 row_newbcast:1 row_mask:0xf bank_mask:0x8
    v_smfmac_f32_16x16x64_bf16 v[192:195], v[28:31], v[104:111], v210
    s_waitcnt vmcnt(8)
    v_smfmac_f32_16x16x64_bf16 v[196:199], v[28:31], v[112:119], v210
    v_mov_b32_dpp v206, v12 row_newbcast:4 row_mask:0xf bank_mask:0x1
    v_mov_b32_dpp v206, v12 row_newbcast:5 row_mask:0xf bank_mask:0x4
    v_mov_b32_dpp v207, v12 row_newbcast:4 row_mask:0xf bank_mask:0x2
    v_mov_b32_dpp v207, v12 row_newbcast:5 row_mask:0xf bank_mask:0x8
    s_nop 1
    s_waitcnt vmcnt(6)
    v_smfmac_f32_16x16x64_bf16 v[200:203], v[204:207], v[120:127], v210
    ds_write_b128 v212, v[192:195] offset:0
    ds_write_b128 v212, v[196:199] offset:1024
    s_mov_b64 exec, s[48:49]
    s_nop 4
    ds_write_b128 v213, v[200:203] offset:2048
    s_mov_b64 exec, -1
    s_cmp_ge_u32 s44, 5
    s_waitcnt lgkmcnt(0)
    s_barrier
    s_cbranch_scc1 L_cons
    ds_read_b128 v[48:51], v214 offset:0
    ds_read_b128 v[52:55], v214 offset:3072
    ds_read_b128 v[56:59], v214 offset:6144
    ds_read_b128 v[60:63], v214 offset:9216
    s_cmp_eq_u32 s44, 4
    s_waitcnt lgkmcnt(2)
    v_pk_add_f32 v[48:49], v[48:49], v[52:53]
    v_pk_add_f32 v[50:51], v[50:51], v[54:55]
    s_waitcnt lgkmcnt(0)
    v_pk_add_f32 v[56:57], v[56:57], v[60:61]
    v_pk_add_f32 v[58:59], v[58:59], v[62:63]
    v_pk_add_f32 v[48:49], v[48:49], v[56:57]
    v_pk_add_f32 v[50:51], v[50:51], v[58:59]
    s_cbranch_scc1 L_red4
    s_nop 0
    v_permlane32_swap_b32 v48, v50
    v_permlane32_swap_b32 v49, v51
    s_nop 0
    v_pk_add_f32 v[48:49], v[48:49], v[50:51]
    v_bfi_b32 v48, v7, v219, v48
    v_bfi_b32 v49, v7, v220, v49
    buffer_store_dwordx2 v[48:49], v215, s[12:15], s74 offen sc1
    s_endpgm
L_red4:
    s_nop 0
    v_permlane16_swap_b32 v48, v49
    v_permlane16_swap_b32 v50, v51
    s_nop 0
    v_add_f32 v48, v48, v49
    v_add_f32 v50, v50, v51
    s_nop 1
    v_permlane32_swap_b32 v48, v50
    s_nop 0
    v_add_f32 v48, v48, v50
    v_bfi_b32 v48, v7, v219, v48
    buffer_store_dword v48, v215, s[12:15], s74 offen sc1
    s_endpgm
L_cons:
    s_cmp_eq_u32 s54, 0
    s_cbranch_scc1 L_keeper
    s_mov_b32 s47, 8000000
    s_waitcnt vmcnt(0)
    s_branch L_pfast
L_ptop:
    s_wqm_b64 exec, s[4:5]
    buffer_load_dwordx4 v[176:179], v221, s[12:15], s66 offen sc1
    s_wqm_b64 exec, s[6:7]
    buffer_load_dwordx4 v[180:183], v221, s[12:15], s67 offen sc1
    s_wqm_b64 exec, s[8:9]
    buffer_load_dwordx4 v[184:187], v221, s[12:15], s68 offen sc1
    s_wqm_b64 exec, s[10:11]
    buffer_load_dwordx4 v[188:191], v221, s[12:15], s69 offen sc1
    s_wqm_b64 exec, s[16:17]
    buffer_load_dwordx4 v[224:227], v222, s[12:15], s70 offen sc1
    s_mov_b64 exec, -1
    s_waitcnt vmcnt(10)
    s_cmp_le_u32 s48, 96
    s_cbranch_scc1 L_pfast
    s_waitcnt vmcnt(0)
L_pfast:
    v_xor_b32 v72, s28, v176
    v_xor_b32 v73, s29, v177
    v_xor_b32 v74, s30, v178
    v_xor_b32 v75, s31, v179
    v_or3_b32 v5, v72, v73, v74
    v_bitop3_b32 v5, v5, v75, v7 bitop3:0xa8
    v_cmp_ne_u32 s[4:5], 0, v5
    v_xor_b32 v76, s28, v180
    v_xor_b32 v77, s29, v181
    v_xor_b32 v78, s30, v182
    v_xor_b32 v79, s31, v183
    v_or3_b32 v5, v76, v77, v78
    v_bitop3_b32 v5, v5, v79, v7 bitop3:0xa8
    v_cmp_ne_u32 s[6:7], 0, v5
    v_xor_b32 v80, s28, v184
    v_xor_b32 v81, s29, v185
    v_xor_b32 v82, s30, v186
    v_xor_b32 v83, s31, v187
    v_or3_b32 v5, v80, v81, v82
    v_bitop3_b32 v5, v5, v83, v7 bitop3:0xa8
    v_cmp_ne_u32 s[8:9], 0, v5
    v_xor_b32 v84, s28, v188
    v_xor_b32 v85, s29, v189
    v_xor_b32 v86, s30, v190
    v_xor_b32 v87, s31, v191
    v_or3_b32 v5, v84, v85, v86
    v_bitop3_b32 v5, v5, v87, v7 bitop3:0xa8
    v_cmp_ne_u32 s[10:11], 0, v5
    v_xor_b32 v88, s28, v224
    v_xor_b32 v89, s29, v225
    v_xor_b32 v90, s30, v226
    v_xor_b32 v91, s31, v227
    v_or3_b32 v5, v88, v89, v90
    v_bitop3_b32 v5, v5, v91, v7 bitop3:0xa8
    v_cmp_ne_u32 s[16:17], 0, v5
    v_pk_add_f32 v[72:73], v[72:73], v[76:77]
    v_pk_add_f32 v[74:75], v[74:75], v[78:79]
    v_pk_add_f32 v[80:81], v[80:81], v[84:85]
    v_pk_add_f32 v[82:83], v[82:83], v[86:87]
    s_bcnt1_i32_b64 s48, s[4:5]
    s_bcnt1_i32_b64 s46, s[6:7]
    s_add_u32 s48, s48, s46
    s_bcnt1_i32_b64 s46, s[8:9]
    s_add_u32 s48, s48, s46
    s_bcnt1_i32_b64 s46, s[10:11]
    s_add_u32 s48, s48, s46
    s_bcnt1_i32_b64 s46, s[16:17]
    s_add_u32 s48, s48, s46
    s_sub_u32 s47, s47, 1
    s_cbranch_scc1 L_pok
    s_cmp_lg_u32 s48, 0
    s_cbranch_scc1 L_ptop
L_pok:
    v_pk_add_f32 v[72:73], v[72:73], v[80:81]
    v_pk_add_f32 v[74:75], v[74:75], v[82:83]
    v_mul_f32 v88, v88, v251
    v_mul_f32 v89, v89, v251
    v_mul_f32 v90, v90, v251
    v_mul_f32 v91, v91, v251
    v_fma_f32 v72, v72, s57, v88
    v_fma_f32 v73, v73, s57, v89
    v_fma_f32 v74, v74, s57, v90
    v_fma_f32 v75, v75, s57, v91
    s_nop 0
    v_permlane16_swap_b32 v72, v73
    v_permlane16_swap_b32 v74, v75
    s_nop 0
    v_add_f32 v72, v72, v73
    v_add_f32 v74, v74, v75
    s_nop 1
    v_permlane32_swap_b32 v72, v74
    s_nop 0
    v_add_f32 v72, v72, v74
    s_nop 1
    v_add_f32_dpp v72, v72, v72 row_ror:8 row_mask:0xf bank_mask:0xf
    v_add_f32 v72, v72, v250
    v_cvt_pk_bf16_f32 v72, v72, v72
    s_mov_b32 exec_lo, 0x00ff00ff
    s_mov_b32 exec_hi, 0x00ff00ff
    buffer_store_short v72, v249, s[32:35], s53 offen
    s_endpgm
L_keeper:
    s_cmp_lg_u32 s2, 255
    s_cbranch_scc1 L_fin
    s_cmp_lg_u32 s44, 5
    s_cbranch_scc1 L_fin
    v_mul_u32_u24 v2, 3328, v1
    s_mov_b32 s64, 622592
    s_add_u32 s65, s64, 212992
    s_add_u32 s66, s65, 212992
    s_add_u32 s67, s66, 212992
    s_mov_b64 s[4:5], -1
    v_not_b32 v48, s28
    v_not_b32 v49, s29
    v_not_b32 v50, s30
    v_not_b32 v51, s31
    s_mov_b64 s[6:7], -1
    v_not_b32 v52, s28
    v_not_b32 v53, s29
    v_not_b32 v54, s30
    v_not_b32 v55, s31
    s_mov_b64 s[8:9], -1
    v_not_b32 v56, s28
    v_not_b32 v57, s29
    v_not_b32 v58, s30
    v_not_b32 v59, s31
    s_mov_b64 s[10:11], -1
    v_not_b32 v60, s28
    v_not_b32 v61, s29
    v_not_b32 v62, s30
    v_not_b32 v63, s31
    s_mov_b32 s47, 8000000
    s_movk_i32 s48, 256
L_ktop:
    s_mov_b64 exec, s[4:5]
    buffer_load_dwordx4 v[48:51], v2, s[12:15], s64 offen sc1
    s_mov_b64 exec, s[6:7]
    buffer_load_dwordx4 v[52:55], v2, s[12:15], s65 offen sc1
    s_mov_b64 exec, s[8:9]
    buffer_load_dwordx4 v[56:59], v2, s[12:15], s66 offen sc1
    s_mov_b64 exec, s[10:11]
    buffer_load_dwordx4 v[60:63], v2, s[12:15], s67 offen sc1
    s_mov_b64 exec, -1
    s_waitcnt vmcnt(8)
    s_cmp_le_u32 s48, 48
    s_cbranch_scc1 L_kfast
    s_waitcnt vmcnt(0)
L_kfast:
    v_xor_b32 v5, s28, v48
    v_bitop3_b32 v5, v49, s29, v5 bitop3:0xbe
    v_bitop3_b32 v5, v50, s30, v5 bitop3:0xbe
    v_bitop3_b32 v5, v51, s31, v5 bitop3:0xbe
    v_and_b32 v5, v5, v7
    v_cmp_ne_u32 s[4:5], 0, v5
    v_xor_b32 v5, s28, v52
    v_bitop3_b32 v5, v53, s29, v5 bitop3:0xbe
    v_bitop3_b32 v5, v54, s30, v5 bitop3:0xbe
    v_bitop3_b32 v5, v55, s31, v5 bitop3:0xbe
    v_and_b32 v5, v5, v7
    v_cmp_ne_u32 s[6:7], 0, v5
    v_xor_b32 v5, s28, v56
    v_bitop3_b32 v5, v57, s29, v5 bitop3:0xbe
    v_bitop3_b32 v5, v58, s30, v5 bitop3:0xbe
    v_bitop3_b32 v5, v59, s31, v5 bitop3:0xbe
    v_and_b32 v5, v5, v7
    v_cmp_ne_u32 s[8:9], 0, v5
    v_xor_b32 v5, s28, v60
    v_bitop3_b32 v5, v61, s29, v5 bitop3:0xbe
    v_bitop3_b32 v5, v62, s30, v5 bitop3:0xbe
    v_bitop3_b32 v5, v63, s31, v5 bitop3:0xbe
    v_and_b32 v5, v5, v7
    v_cmp_ne_u32 s[10:11], 0, v5
    s_nop 1
    s_bcnt1_i32_b64 s48, s[4:5]
    s_bcnt1_i32_b64 s46, s[6:7]
    s_add_u32 s48, s48, s46
    s_bcnt1_i32_b64 s46, s[8:9]
    s_add_u32 s48, s48, s46
    s_bcnt1_i32_b64 s46, s[10:11]
    s_add_u32 s48, s48, s46
    s_sub_u32 s47, s47, 1
    s_cbranch_scc1 L_kok
    s_cmp_lg_u32 s48, 0
    s_cbranch_scc1 L_ktop
L_kok:
    v_mov_b32 v5, s40
    v_mov_b32 v6, 0
    s_mov_b64 exec, 1
    buffer_store_dword v5, v6, s[12:15], 0 offen offset:0
    s_mov_b64 exec, -1
L_fin:
L_end:
    s_endpgm
.section .rodata,"a"
.p2align 6
.amdhsa_kernel gated_mix__sliding_block_cached__mixer_channel_mlp__decode_kernel
  .amdhsa_next_free_vgpr 256
  .amdhsa_next_free_sgpr 102
  .amdhsa_accum_offset 256
  .amdhsa_group_segment_fixed_size 0
  .amdhsa_kernarg_size 112
  .amdhsa_user_sgpr_count 2
  .amdhsa_user_sgpr_kernarg_segment_ptr 1
  .amdhsa_system_sgpr_workgroup_id_x 1
.end_amdhsa_kernel
```
